```python
import torch

def _softmax(x, axis=-1):
    return torch.softmax(x, dim=axis)
def _gelu(x):
    return torch.nn.functional.gelu(x, approximate="tanh")
def _silu(x):
    return torch.nn.functional.silu(x)
def _sigmoid(x):
    return torch.sigmoid(x)
def _layernorm(x, axis=-1, eps=1e-5):
    m = x.mean(dim=axis, keepdim=True)
    v = x.var(dim=axis, keepdim=True, unbiased=False)
    return (x - m) / torch.sqrt(v + eps)
def _scatter_add(tgt, idx, src, axis=0):
    return tgt.clone().index_add_(axis, idx, src)
def _segment_sum(src, seg, n):
    out = torch.zeros((n,) + src.shape[1:], dtype=src.dtype)
    return out.index_add_(0, seg, src)
def _pad(x, pw):
    flat = tuple(v for pair in reversed(pw) for v in pair)
    return torch.nn.functional.pad(x, flat)

kernel_name = 'gather_scatter__edge_featured_mpnn_egc__graph'

def setup_inputs():

    _w = (lambda a: (lambda t: t.to(torch.bfloat16) if t.is_floating_point() else t)(torch.as_tensor(a)))
    N, deg, D, De = 25000, 32, 64, max(0, 1)
    E = N * deg
    return {
        "x": _w((lambda *s: torch.randn(*s, dtype=torch.bfloat16) * 0.2)(N, D)),
        "e_attr": _w((lambda *s: torch.randn(*s, dtype=torch.bfloat16) * 0.2)(E, De)),
        "src": _w((lambda lo, hi, *s: torch.randint(lo, hi, s))(0, N, E).to(torch.int64)),
        "dst": _w((lambda lo, hi, *s: torch.randint(lo, hi, s))(0, N, E).to(torch.int64)),
        "u_w": _w((lambda *s: torch.randn(*s, dtype=torch.bfloat16) * 0.05)(D, D)),
        "v_w": _w((lambda *s: torch.randn(*s, dtype=torch.bfloat16) * 0.05)(D, D)),
        "g_w": _w((lambda *s: torch.randn(*s, dtype=torch.bfloat16) * 0.2)(2 * D + De, D)),
    }

def reference(x, e_attr, src, dst, u_w, v_w, g_w):
    N, D = x.shape
    g_in = torch.concatenate([x[dst], x[src], e_attr], axis=-1)
    eta = _sigmoid(g_in @ g_w)
    hv = x @ v_w
    msg = eta * hv[src]
    agg = _segment_sum(msg, dst, N)
    return _silu(x @ u_w + agg)
```

```asm
; @launch kernel=gather_scatter__edge_featured_mpnn_egc__graph_kernel grid=(256,1,1) block=(1024,1,1) lds=154112
.amdgcn_target "amdgcn-amd-amdhsa--gfx950"
.text
.globl gather_scatter__edge_featured_mpnn_egc__graph_kernel
.p2align 8
.type gather_scatter__edge_featured_mpnn_egc__graph_kernel,@function
gather_scatter__edge_featured_mpnn_egc__graph_kernel:
    s_load_dwordx16 s[64:79], s[0:1], 0
    s_load_dwordx2 s[6:7], s[0:1], 72
    s_cmp_ge_u32 s2, 16
    s_cbranch_scc1 K_IT
    s_getpc_b64 s[28:29]
K_PC0:
    v_lshlrev_b32 v2, 7, v0
    s_mov_b32 s30, K2_CODE_END-K_PC0
    s_mov_b32 s31, 0x20000
    buffer_load_dword v122, v2, s[28:31], 0 offen
K_IT:
    s_memrealtime s[4:5]
    s_cmp_ge_u32 s2, 256
    s_cbranch_scc1 K2_END
    v_and_b32 v1, 63, v0
    v_readfirstlane_b32 s3, v0
    s_lshr_b32 s3, s3, 6
    s_and_b32 s32, s2, 3
    s_lshl_b32 s32, s32, 5
    s_lshr_b32 s35, s2, 3
    s_add_u32 s32, s32, s35
    s_bfe_u32 s33, s2, 0x10002
    s_mov_b32 s34, 0
    s_cmp_lt_u32 s3, 8
    s_cbranch_scc1 K_TAB
    v_and_b32 v62, 0x1ff, v0
    s_mul_i32 s39, s2, 784
    v_add_u32 v6, s39, v62
    v_cmp_gt_u32 vcc, 272, v62
    s_mov_b32 s52, 200000
    s_mov_b32 s53, 199488
    v_cmp_gt_u32 s[42:43], s52, v6
    v_cmp_gt_u32 s[44:45], s53, v6
    v_lshlrev_b32 v2, 4, v6
    v_lshlrev_b32 v3, 3, v6
    s_and_b64 s[44:45], s[44:45], vcc
    s_movk_i32 s52, 8192
    s_movk_i32 s53, 4096
    s_mov_b32 s30, 3200000
    s_mov_b32 s31, 0x20000
    s_mov_b32 s58, 3200000
    s_mov_b32 s59, 0x20000
    s_mov_b32 s62, 1600000
    s_mov_b32 s63, 0x20000
    s_mov_b32 s47, 53904
    s_cmp_lt_u32 s3, 10
    s_cselect_b32 s39, 3, 0
    s_cselect_b32 s46, 130304, s47
    v_lshl_add_u32 v4, v62, 2, s46
    v_mov_b32 v5, s39
    v_cmp_gt_u32 vcc, 132, v62
    s_mov_b64 exec, vcc
    ds_write_b32 v4, v5
    s_cmp_ge_u32 s3, 13
    s_mov_b64 exec, s[42:43]
    s_waitcnt lgkmcnt(0)
    s_mov_b64 s[28:29], s[70:71]
    s_mov_b64 s[56:57], s[68:69]
    s_mov_b64 s[60:61], s[66:67]
    buffer_load_dwordx4 v[8:11], v2, s[28:31], 0 offen
    s_cbranch_scc1 K_L1
    s_mov_b64 exec, s[44:45]
    buffer_load_dwordx4 v[12:15], v2, s[28:31], s52 offen
    s_mov_b64 exec, s[42:43]
K_L1:
    s_barrier
    buffer_load_dwordx4 v[16:19], v2, s[56:59], 0 offen
    buffer_load_dwordx2 v[24:25], v3, s[60:63], 0 offen
    s_cbranch_scc1 K_L2
    s_mov_b64 exec, s[44:45]
    buffer_load_dwordx4 v[20:23], v2, s[56:59], s52 offen
    buffer_load_dwordx2 v[26:27], v3, s[60:63], s53 offen
K_L2:
    s_mov_b64 exec, -1
    s_branch K_PART2
K_TAB:
    s_mul_i32 s43, s32, 25088
    s_movk_i32 s42, 112
    s_and_b32 s48, s3, 1
    s_lshl_b32 s49, s48, 11
    s_add_u32 s50, s49, s43
    v_lshrrev_b32 v121, 3, v1
    v_lshl_add_u32 v121, v121, 7, s50
    v_lshlrev_b32 v30, 4, v1
    v_xor_b32 v31, v30, v1
    v_and_or_b32 v121, v31, s42, v121
    v_lshrrev_b32 v126, 2, v1
    v_lshlrev_b32 v126, 7, v126
    v_and_or_b32 v126, v30, 48, v126
    s_lshr_b32 s51, s3, 1
    s_mul_i32 s52, s33, 3
    s_add_u32 s53, s51, s52
    s_lshl_b32 s53, s53, 12
    v_add_u32 v28, s53, v121
    v_xor_b32 v29, 64, v28
    s_add_u32 s54, s53, s49
    s_add_u32 m0, s54, 80128
    s_lshl_b32 s44, s3, 11
    s_add_u32 s44, s44, 105728
    s_lshl_b32 s45, s48, 12
    s_and_b32 s46, s3, 2
    s_lshl_b32 s46, s46, 5
    s_add_u32 s45, s45, s46
    s_cmp_lt_u32 s3, 4
    s_cselect_b32 s47, 8192, 0
    s_add_u32 s45, s45, s47
    s_add_u32 s47, s45, 1024
    s_mov_b32 s30, 16512
    s_mov_b32 s31, 0x20000
    s_add_u32 s55, s33, 6
    s_waitcnt lgkmcnt(0)
    s_mov_b64 s[8:9], s[64:65]
    s_mov_b32 s10, 3200000
    s_mov_b32 s11, 0x20000
    s_cmp_ge_u32 s3, s55
    s_cbranch_scc1 K_WD
    buffer_load_dwordx4 v28, s[8:11], 0 offen lds
    s_cmp_eq_u32 s3, 6
    s_cbranch_scc1 K_WD
    buffer_load_dwordx4 v29, s[8:11], 0 offen offset:1024 lds
K_WD:
    s_barrier
    s_cmp_lt_u32 s3, 4
    s_cselect_b64 s[28:29], s[76:77], s[74:75]
    s_mov_b32 m0, s44
    s_nop 0
    buffer_load_dwordx4 v126, s[28:31], s45 offen lds
    buffer_load_dwordx4 v126, s[28:31], s47 offen offset:1024 lds
    s_add_u32 s37, s53, 80128
    v_and_b32 v29, 31, v1
    v_lshl_add_u32 v29, v29, 7, s37
    v_bfe_u32 v30, v1, 1, 3
    v_lshrrev_b32 v120, 5, v1
    v_xor_b32 v30, v30, v120
    v_lshl_add_u32 v36, v30, 4, v29
    v_xor_b32 v37, 32, v36
    v_xor_b32 v38, 64, v36
    v_xor_b32 v39, 96, v36
    v_lshlrev_b32 v120, 9, v120
    v_bfe_u32 v29, v1, 2, 2
    v_lshl_add_u32 v120, v29, 6, v120
    v_bfe_u32 v29, v1, 4, 1
    v_lshl_add_u32 v120, v29, 5, v120
    v_and_b32 v29, 3, v1
    v_lshl_add_u32 v120, v29, 3, v120
    v_add_u32 v120, 105728, v120
    s_lshl_b32 s54, s48, 12
    v_add_u32 v120, s54, v120
    s_lshl_b32 s54, s3, 12
    s_cmp_eq_u32 s3, 7
    s_cselect_b32 s54, 25088, s54
    s_add_u32 s54, s54, 54528
    v_lshrrev_b32 v123, 5, v1
    v_lshlrev_b32 v123, 9, v123
    v_and_b32 v30, 31, v1
    v_lshl_add_u32 v123, v30, 2, v123
    v_add_u32 v4, s54, v123
    v_lshl_add_u32 v5, v1, 4, s54
    s_add_u32 s54, s53, s43
    v_lshl_add_u32 v6, v1, 4, s54
    s_mov_b64 s[12:13], s[6:7]
    s_mov_b32 s14, 5604352
    s_mov_b32 s15, 0x20000
    s_mov_b64 s[16:17], s[78:79]
    s_mov_b32 s18, 3200000
    s_mov_b32 s19, 0x20000
    s_mul_i32 s36, s33, 3276800
    s_add_u32 s36, s36, 5636096
    s_add_u32 s20, s6, s36
    s_addc_u32 s21, s7, 0
    s_mov_b32 s22, 3200000
    s_mov_b32 s23, 0x20000
    s_mov_b32 s24, s20
    s_add_u32 s25, s21, 8388608
    s_mov_b32 s26, 25000
    s_mov_b32 s27, 0x20000
    s_mov_b32 s40, 0xbfb8aa3b
    s_mov_b32 s41, s40
    s_mul_i32 s54, s48, 3276800
    s_add_u32 s54, s54, 5636096
    s_add_u32 s56, s6, s54
    s_addc_u32 s57, s7, 0
    s_mov_b32 s58, 3200000
    s_mov_b32 s59, 0x20000
    s_sub_u32 s52, 3, s52
    s_add_u32 s53, s51, s52
    s_cmp_eq_u32 s3, 6
    s_cselect_b32 s53, 6, s53
    s_lshl_b32 s53, s53, 12
    v_add_u32 v124, s53, v121
    v_xor_b32 v125, 64, v124
    s_add_u32 s53, s53, s49
    s_add_u32 s53, s53, 80128
    s_lshl_b32 s44, s3, 10
    s_add_u32 s44, s44, 122112
    s_and_b32 s45, s3, 3
    s_lshl_b32 s45, s45, 11
    s_lshl_b32 s46, s33, 6
    s_add_u32 s45, s45, s46
    s_cmp_lt_u32 s3, 4
    s_cselect_b64 s[28:29], s[76:77], s[72:73]
    s_mov_b32 m0, s44
    s_nop 0
    buffer_load_dwordx4 v126, s[28:31], s45 offen lds
    s_cmp_lg_u32 s3, 7
    s_cbranch_scc1 K_NFT
    s_mov_b64 s[28:29], s[76:77]
    s_mov_b32 m0, 54336
    s_add_u32 s46, s46, 16384
    s_mov_b64 exec, 15
    buffer_load_dwordx4 v126, s[28:31], s46 offen lds
    s_and_b32 s36, s2, 7
    s_mul_i32 s36, s36, 8320
    s_lshr_b32 s35, s2, 3
    s_lshl_b32 s35, s35, 8
    s_add_u32 s36, s36, s35
    s_add_u32 s36, s36, 5341184
    v_lshlrev_b32 v12, 7, v1
    s_mov_b64 exec, 3
    buffer_load_dword v122, v12, s[12:15], s36 offen sc0 sc1
    s_mov_b64 exec, -1
    s_waitcnt vmcnt(3)
    s_branch K_NFT2
K_NFT:
    s_waitcnt vmcnt(1)
K_NFT2:
    v_mov_b32 v10, 54416
    v_mov_b32 v11, 1
    s_mov_b64 exec, 1
    ds_add_u32 v10, v11
    s_branch GT_T
GS_T:
    s_sleep 1
GT_T:
    ds_read_b32 v11, v10
    s_waitcnt lgkmcnt(0)
    v_cmp_gt_u32 vcc, 8, v11
    s_cbranch_vccnz GS_T
    s_mov_b64 exec, -1
    s_lshl_b32 s54, s33, 1
    s_add_u32 s54, s54, 6
    s_cmp_ge_u32 s3, s54
    s_cbranch_scc1 K_B2
    ds_read_b128 v[40:43], v36
    ds_read_b64_tr_b16 v[56:57], v120 offset:0
    ds_read_b64_tr_b16 v[58:59], v120 offset:256
    ds_read_b64_tr_b16 v[72:73], v120 offset:8192
    ds_read_b64_tr_b16 v[74:75], v120 offset:8448
    ds_read_b128 v[44:47], v37
    ds_read_b64_tr_b16 v[60:61], v120 offset:1024
    ds_read_b64_tr_b16 v[62:63], v120 offset:1280
    ds_read_b64_tr_b16 v[76:77], v120 offset:9216
    ds_read_b64_tr_b16 v[78:79], v120 offset:9472
    ds_read_b128 v[48:51], v38
    ds_read_b64_tr_b16 v[64:65], v120 offset:2048
    ds_read_b64_tr_b16 v[66:67], v120 offset:2304
    ds_read_b64_tr_b16 v[80:81], v120 offset:10240
    ds_read_b64_tr_b16 v[82:83], v120 offset:10496
    s_waitcnt lgkmcnt(12)
    v_mfma_f32_32x32x16_bf16 v[88:103], v[40:43], v[56:59], 0
    s_waitcnt lgkmcnt(10)
    v_mfma_f32_32x32x16_bf16 v[104:119], v[40:43], v[72:75], 0
    ds_read_b128 v[52:55], v39
    ds_read_b64_tr_b16 v[68:69], v120 offset:3072
    ds_read_b64_tr_b16 v[70:71], v120 offset:3328
    ds_read_b64_tr_b16 v[84:85], v120 offset:11264
    ds_read_b64_tr_b16 v[86:87], v120 offset:11520
    s_waitcnt lgkmcnt(12)
    v_mfma_f32_32x32x16_bf16 v[88:103], v[44:47], v[60:63], v[88:103]
    s_waitcnt lgkmcnt(10)
    v_mfma_f32_32x32x16_bf16 v[104:119], v[44:47], v[76:79], v[104:119]
    s_waitcnt lgkmcnt(7)
    v_mfma_f32_32x32x16_bf16 v[88:103], v[48:51], v[64:67], v[88:103]
    s_waitcnt lgkmcnt(5)
    v_mfma_f32_32x32x16_bf16 v[104:119], v[48:51], v[80:83], v[104:119]
    s_waitcnt lgkmcnt(2)
    v_mfma_f32_32x32x16_bf16 v[88:103], v[52:55], v[68:71], v[88:103]
    s_waitcnt lgkmcnt(0)
    v_mfma_f32_32x32x16_bf16 v[104:119], v[52:55], v[84:87], v[104:119]
    s_cmp_ge_u32 s3, 6
    s_cselect_b32 exec_hi, 0, -1
    s_nop 7
    v_pk_mul_f32 v[88:89], v[88:89], s[40:41]
    v_pk_mul_f32 v[90:91], v[90:91], s[40:41]
    v_cvt_pk_bf16_f32 v88, v88, v104
    ds_write_b32 v4, v88 offset:0
    v_cvt_pk_bf16_f32 v89, v89, v105
    ds_write_b32 v4, v89 offset:128
    v_cvt_pk_bf16_f32 v90, v90, v106
    ds_write_b32 v4, v90 offset:256
    v_cvt_pk_bf16_f32 v91, v91, v107
    ds_write_b32 v4, v91 offset:384
    ds_read_b128 v[56:59], v5 offset:0
    s_cbranch_scc1 K_T6
    v_pk_mul_f32 v[92:93], v[92:93], s[40:41]
    v_pk_mul_f32 v[94:95], v[94:95], s[40:41]
    v_cvt_pk_bf16_f32 v92, v92, v108
    ds_write_b32 v4, v92 offset:1024
    v_cvt_pk_bf16_f32 v93, v93, v109
    ds_write_b32 v4, v93 offset:1152
    v_cvt_pk_bf16_f32 v94, v94, v110
    ds_write_b32 v4, v94 offset:1280
    v_cvt_pk_bf16_f32 v95, v95, v111
    ds_write_b32 v4, v95 offset:1408
    ds_read_b128 v[60:63], v5 offset:1024
    v_pk_mul_f32 v[96:97], v[96:97], s[40:41]
    v_pk_mul_f32 v[98:99], v[98:99], s[40:41]
    v_cvt_pk_bf16_f32 v96, v96, v112
    ds_write_b32 v4, v96 offset:2048
    v_cvt_pk_bf16_f32 v97, v97, v113
    ds_write_b32 v4, v97 offset:2176
    v_cvt_pk_bf16_f32 v98, v98, v114
    ds_write_b32 v4, v98 offset:2304
    v_cvt_pk_bf16_f32 v99, v99, v115
    ds_write_b32 v4, v99 offset:2432
    ds_read_b128 v[64:67], v5 offset:2048
    s_waitcnt lgkmcnt(5)
    v_pk_mul_f32 v[100:101], v[100:101], s[40:41]
    v_pk_mul_f32 v[102:103], v[102:103], s[40:41]
    v_cvt_pk_bf16_f32 v100, v100, v116
    ds_write_b32 v4, v100 offset:3072
    v_cvt_pk_bf16_f32 v101, v101, v117
    ds_write_b32 v4, v101 offset:3200
    v_cvt_pk_bf16_f32 v102, v102, v118
    ds_write_b32 v4, v102 offset:3328
    v_cvt_pk_bf16_f32 v103, v103, v119
    ds_write_b32 v4, v103 offset:3456
    ds_read_b128 v[68:71], v5 offset:3072
    v_mov_b32 v10, 54420
    s_mov_b64 exec, 1
GS_G1:
    s_sleep 1
    ds_read_b32 v11, v10
    s_waitcnt lgkmcnt(0)
    v_cmp_gt_u32 vcc, 8, v11
    s_cbranch_vccnz GS_G1
    s_mov_b64 exec, -1
    buffer_store_dwordx4 v[56:59], v6, s[56:59], 0 offen offset:0 sc0 sc1
    buffer_store_dwordx4 v[60:63], v6, s[56:59], 0 offen offset:1024 sc0 sc1
    buffer_store_dwordx4 v[64:67], v6, s[56:59], 0 offen offset:2048 sc0 sc1
    buffer_store_dwordx4 v[68:71], v6, s[56:59], 0 offen offset:3072 sc0 sc1
    s_branch K_B2
K_T6:
    v_mov_b32 v10, 54420
    s_mov_b64 exec, 1
GS_G2:
    s_sleep 1
    ds_read_b32 v11, v10
    s_waitcnt lgkmcnt(0)
    v_cmp_gt_u32 vcc, 8, v11
    s_cbranch_vccnz GS_G2
    s_mov_b64 exec, -1
    s_mov_b32 exec_hi, 0
    buffer_store_dwordx4 v[56:59], v6, s[56:59], 0 offen sc0 sc1
    s_mov_b64 exec, -1
K_B2:
    v_mov_b32 v10, 54424
    s_mov_b64 exec, 1
GS_TI:
    s_sleep 4
    ds_read_b32 v11, v10
    s_waitcnt lgkmcnt(0)
    v_cmp_gt_u32 vcc, 8, v11
    s_cbranch_vccnz GS_TI
    s_mov_b64 exec, -1
    s_branch K_FILL
K_PART2:
    s_cmp_ge_u32 s3, 13
    s_cbranch_scc1 K_P1
    v_mov_b64 v[124:125], 0
    v_mov_b32 v126, 0
    s_mov_b32 s46, 0xffffff3c
    s_mov_b32 s47, 0xffff0000
    s_mov_b32 s48, 130304
    s_movk_i32 s49, 80
    s_mov_b32 s51, 131328
    v_mov_b32 v5, 1
    s_mov_b64 s[8:9], s[64:65]
    s_mov_b32 s10, 3200000
    s_mov_b32 s11, 0x20000
    s_mov_b64 s[12:13], s[6:7]
    s_mov_b32 s14, 5604352
    s_mov_b32 s15, 0x20000
    s_mov_b64 s[16:17], s[78:79]
    s_mov_b32 s18, 3200000
    s_mov_b32 s19, 0x20000
    s_mul_i32 s36, s33, 3276800
    s_add_u32 s36, s36, 5636096
    s_add_u32 s20, s6, s36
    s_addc_u32 s21, s7, 0
    s_mov_b32 s22, 3200000
    s_mov_b32 s23, 0x20000
    s_mov_b32 s24, s20
    s_add_u32 s25, s21, 8388608
    s_mov_b32 s26, 25000
    s_mov_b32 s27, 0x20000
    s_mov_b32 s40, 0xbfb8aa3b
    s_mov_b32 s41, s40
    v_mul_u32_u24 v67, 683, v62
    v_lshrrev_b32 v67, 11, v67
    v_mad_i32_i24 v68, v67, -3, v62
    v_mul_u32_u24 v69, 80, v67
    v_add_u32 v69, s51, v69
    v_lshl_add_u32 v67, v67, 2, s48
    v_cmp_eq_u32 vcc, 1, v68
    v_mov_b32 v71, 0x2c1c0c28
    v_mov_b32 v72, 0x18082414
    v_cndmask_b32 v71, v71, v72, vcc
    v_cmp_eq_u32 vcc, 0, v68
    v_mov_b32 v72, 0x04201000
    v_mov_b32 v68, 0xffffff
    v_cndmask_b32 v71, v71, v72, vcc
    v_cndmask_b32 v72, 0, v68, vcc
    v_add_u32_sdwa v73, v71, v69 dst_sel:DWORD dst_unused:UNUSED_PAD src0_sel:BYTE_0 src1_sel:DWORD
    v_add_u32_sdwa v74, v71, v69 dst_sel:DWORD dst_unused:UNUSED_PAD src0_sel:BYTE_1 src1_sel:DWORD
    v_add_u32_sdwa v75, v71, v69 dst_sel:DWORD dst_unused:UNUSED_PAD src0_sel:BYTE_2 src1_sel:DWORD
    v_add_u32_sdwa v76, v71, v69 dst_sel:DWORD dst_unused:UNUSED_PAD src0_sel:BYTE_3 src1_sel:DWORD
    v_lshlrev_b32 v70, 4, v62
    v_add_u32 v66, 141568, v70
    v_lshl_add_u32 v64, v1, 3, s48
    s_mul_i32 s50, s2, 20864
    s_add_u32 s54, s50, 6144
    s_add_u32 s55, s54, 8192
    s_waitcnt vmcnt(5)
    s_mov_b64 exec, s[42:43]
    v_mul_u32_u24 v48, 21400, v8
    v_lshrrev_b32 v48, 22, v48
    v_lshl_add_u32 v32, v48, 2, s48
    ds_add_rtn_u32 v40, v32, v5
    v_mad_i32_i24 v8, v48, s46, v8
    v_mul_u32_u24 v49, 21400, v9
    v_lshrrev_b32 v49, 22, v49
    v_lshl_add_u32 v33, v49, 2, s48
    ds_add_rtn_u32 v41, v33, v5
    v_mad_i32_i24 v9, v49, s46, v9
    v_mul_u32_u24 v50, 21400, v10
    v_lshrrev_b32 v50, 22, v50
    v_lshl_add_u32 v34, v50, 2, s48
    ds_add_rtn_u32 v42, v34, v5
    v_mad_i32_i24 v10, v50, s46, v10
    v_mul_u32_u24 v51, 21400, v11
    v_lshrrev_b32 v51, 22, v51
    v_lshl_add_u32 v35, v51, 2, s48
    ds_add_rtn_u32 v43, v35, v5
    v_mad_i32_i24 v11, v51, s46, v11
    s_waitcnt vmcnt(4)
    s_mov_b64 exec, s[44:45]
    v_mul_u32_u24 v52, 21400, v12
    v_lshrrev_b32 v52, 22, v52
    v_lshl_add_u32 v36, v52, 2, s48
    ds_add_rtn_u32 v44, v36, v5
    v_mad_i32_i24 v12, v52, s46, v12
    v_mul_u32_u24 v53, 21400, v13
    v_lshrrev_b32 v53, 22, v53
    v_lshl_add_u32 v37, v53, 2, s48
    ds_add_rtn_u32 v45, v37, v5
    v_mad_i32_i24 v13, v53, s46, v13
    v_mul_u32_u24 v54, 21400, v14
    v_lshrrev_b32 v54, 22, v54
    v_lshl_add_u32 v38, v54, 2, s48
    ds_add_rtn_u32 v46, v38, v5
    v_mad_i32_i24 v14, v54, s46, v14
    v_mul_u32_u24 v55, 21400, v15
    v_lshrrev_b32 v55, 22, v55
    v_lshl_add_u32 v39, v55, 2, s48
    ds_add_rtn_u32 v47, v39, v5
    v_mad_i32_i24 v15, v55, s46, v15
    s_mov_b64 exec, s[42:43]
    s_waitcnt lgkmcnt(7)
    v_and_or_b32 v6, v40, 63, s51
    v_mad_u32_u24 v48, v48, s49, v6
    ds_write_b8 v48, v8
    s_waitcnt lgkmcnt(7)
    v_and_or_b32 v7, v41, 63, s51
    v_mad_u32_u24 v49, v49, s49, v7
    ds_write_b8 v49, v9
    s_waitcnt lgkmcnt(7)
    v_and_or_b32 v6, v42, 63, s51
    v_mad_u32_u24 v50, v50, s49, v6
    ds_write_b8 v50, v10
    s_waitcnt lgkmcnt(7)
    v_and_or_b32 v7, v43, 63, s51
    v_mad_u32_u24 v51, v51, s49, v7
    ds_write_b8 v51, v11
    s_mov_b64 exec, s[44:45]
    s_waitcnt lgkmcnt(7)
    v_and_or_b32 v6, v44, 63, s51
    v_mad_u32_u24 v52, v52, s49, v6
    ds_write_b8 v52, v12
    s_waitcnt lgkmcnt(7)
    v_and_or_b32 v7, v45, 63, s51
    v_mad_u32_u24 v53, v53, s49, v7
    ds_write_b8 v53, v13
    s_waitcnt lgkmcnt(7)
    v_and_or_b32 v6, v46, 63, s51
    v_mad_u32_u24 v54, v54, s49, v6
    ds_write_b8 v54, v14
    s_waitcnt lgkmcnt(7)
    v_and_or_b32 v7, v47, 63, s51
    v_mad_u32_u24 v55, v55, s49, v7
    ds_write_b8 v55, v15
    s_mov_b64 exec, -1
    s_waitcnt lgkmcnt(0)
    v_mov_b32 v4, 54420
    v_mov_b32 v6, 1
    s_mov_b64 exec, 1
    ds_add_u32 v4, v6
    s_branch GT_R2
GS_R2:
    s_sleep 1
GT_R2:
    ds_read_b32 v6, v4
    s_waitcnt lgkmcnt(0)
    v_cmp_gt_u32 vcc, 8, v6
    s_cbranch_vccnz GS_R2
    s_mov_b64 exec, -1
    ds_read_b64 v[28:29], v64
    s_waitcnt lgkmcnt(0)
    v_add3_u32 v7, v28, v29, -6
    v_max_u32 v31, v28, v29
    v_mov_b32 v30, v7
    v_cmp_lt_u32 s[52:53], 48, v31
    s_nop 1
    v_add_u32_dpp v30, v30, v30 row_shr:1 row_mask:0xf bank_mask:0xf bound_ctrl:0
    s_nop 1
    v_add_u32_dpp v30, v30, v30 row_shr:2 row_mask:0xf bank_mask:0xf bound_ctrl:0
    s_nop 1
    v_add_u32_dpp v30, v30, v30 row_shr:4 row_mask:0xf bank_mask:0xf bound_ctrl:0
    s_nop 1
    v_add_u32_dpp v30, v30, v30 row_shr:8 row_mask:0xf bank_mask:0xf bound_ctrl:0
    s_nop 1
    v_add_u32_dpp v30, v30, v30 row_bcast:15 row_mask:0xa bank_mask:0xf
    s_nop 1
    v_add_u32_dpp v30, v30, v30 row_bcast:31 row_mask:0xc bank_mask:0xf
    v_sub_u32 v30, v30, v7
    s_mov_b32 s39, 141556
    v_add3_u32 v31, v30, v28, -3
    v_lshl_add_u32 v30, v30, 2, s39
    v_lshl_add_u32 v31, v31, 2, s39
    ds_write_b64 v64, v[30:31] offset:512
    s_mov_b64 exec, s[42:43]
    ds_read_b32 v32, v32 offset:512
    ds_read_b32 v33, v33 offset:512
    ds_read_b32 v34, v34 offset:512
    ds_read_b32 v35, v35 offset:512
    s_mov_b64 exec, s[44:45]
    ds_read_b32 v36, v36 offset:512
    ds_read_b32 v37, v37 offset:512
    ds_read_b32 v38, v38 offset:512
    ds_read_b32 v39, v39 offset:512
    s_mov_b64 exec, -1
    ds_read2st64_b32 v[6:7], v67 offset0:0 offset1:2
    ds_read_b32 v56, v73
    ds_read_b32 v57, v74
    ds_read_b32 v58, v75
    ds_read_b32 v59, v76
    s_waitcnt lgkmcnt(3)
    v_min_u32 v6, 255, v6
    v_subrev_u32 v7, s39, v7
    v_lshl_or_b32 v6, v7, 8, v6
    v_bfi_b32 v56, v72, v6, v56
K_ND2:
    s_waitcnt lgkmcnt(0)
    v_lshl_add_u32 v32, v40, 2, v32
    v_lshl_add_u32 v33, v41, 2, v33
    v_lshl_add_u32 v34, v42, 2, v34
    v_lshl_add_u32 v35, v43, 2, v35
    v_lshl_add_u32 v36, v44, 2, v36
    v_lshl_add_u32 v37, v45, 2, v37
    v_lshl_add_u32 v38, v46, 2, v38
    v_lshl_add_u32 v39, v47, 2, v39
    s_mov_b64 exec, s[42:43]
    s_waitcnt vmcnt(2)
    v_lshl_or_b32 v16, v24, 16, v16
    ds_write_b32 v32, v16
    v_and_or_b32 v17, v24, s47, v17
    ds_write_b32 v33, v17
    v_lshl_or_b32 v18, v25, 16, v18
    ds_write_b32 v34, v18
    v_and_or_b32 v19, v25, s47, v19
    ds_write_b32 v35, v19
    s_mov_b64 exec, s[44:45]
    s_waitcnt vmcnt(0)
    v_lshl_or_b32 v20, v26, 16, v20
    ds_write_b32 v36, v20
    v_and_or_b32 v21, v26, s47, v21
    ds_write_b32 v37, v21
    v_lshl_or_b32 v22, v27, 16, v22
    ds_write_b32 v38, v22
    v_and_or_b32 v23, v27, s47, v23
    ds_write_b32 v39, v23
    s_mov_b64 exec, -1
    s_branch K_COPY
K_P1:
    v_mov_b64 v[124:125], 0
    v_mov_b32 v126, 0
    s_mov_b32 s46, 0xffffff3c
    s_mov_b32 s47, 0xffff0000
    s_mov_b32 s48, 130304
    s_movk_i32 s49, 80
    s_mov_b32 s51, 131328
    v_mov_b32 v5, 1
    s_mov_b64 s[8:9], s[64:65]
    s_mov_b32 s10, 3200000
    s_mov_b32 s11, 0x20000
    s_mov_b64 s[12:13], s[6:7]
    s_mov_b32 s14, 5604352
    s_mov_b32 s15, 0x20000
    s_mov_b64 s[16:17], s[78:79]
    s_mov_b32 s18, 3200000
    s_mov_b32 s19, 0x20000
    s_mul_i32 s36, s33, 3276800
    s_add_u32 s36, s36, 5636096
    s_add_u32 s20, s6, s36
    s_addc_u32 s21, s7, 0
    s_mov_b32 s22, 3200000
    s_mov_b32 s23, 0x20000
    s_mov_b32 s24, s20
    s_add_u32 s25, s21, 8388608
    s_mov_b32 s26, 25000
    s_mov_b32 s27, 0x20000
    s_mov_b32 s40, 0xbfb8aa3b
    s_mov_b32 s41, s40
    v_mul_u32_u24 v67, 683, v62
    v_lshrrev_b32 v67, 11, v67
    v_mad_i32_i24 v68, v67, -3, v62
    v_mul_u32_u24 v69, 80, v67
    v_add_u32 v69, s51, v69
    v_lshl_add_u32 v67, v67, 2, s48
    v_cmp_eq_u32 vcc, 1, v68
    v_mov_b32 v71, 0x2c1c0c28
    v_mov_b32 v72, 0x18082414
    v_cndmask_b32 v71, v71, v72, vcc
    v_cmp_eq_u32 vcc, 0, v68
    v_mov_b32 v72, 0x04201000
    v_mov_b32 v68, 0xffffff
    v_cndmask_b32 v71, v71, v72, vcc
    v_cndmask_b32 v72, 0, v68, vcc
    v_add_u32_sdwa v73, v71, v69 dst_sel:DWORD dst_unused:UNUSED_PAD src0_sel:BYTE_0 src1_sel:DWORD
    v_add_u32_sdwa v74, v71, v69 dst_sel:DWORD dst_unused:UNUSED_PAD src0_sel:BYTE_1 src1_sel:DWORD
    v_add_u32_sdwa v75, v71, v69 dst_sel:DWORD dst_unused:UNUSED_PAD src0_sel:BYTE_2 src1_sel:DWORD
    v_add_u32_sdwa v76, v71, v69 dst_sel:DWORD dst_unused:UNUSED_PAD src0_sel:BYTE_3 src1_sel:DWORD
    v_lshlrev_b32 v70, 4, v62
    v_add_u32 v66, 141568, v70
    v_lshl_add_u32 v64, v1, 3, s48
    s_mul_i32 s50, s2, 20864
    s_add_u32 s54, s50, 6144
    s_add_u32 s55, s54, 8192
    s_waitcnt vmcnt(2)
    s_mov_b64 exec, s[42:43]
    v_mul_u32_u24 v48, 21400, v8
    v_lshrrev_b32 v48, 22, v48
    v_lshl_add_u32 v32, v48, 2, s48
    ds_add_rtn_u32 v40, v32, v5
    v_mad_i32_i24 v8, v48, s46, v8
    v_mul_u32_u24 v49, 21400, v9
    v_lshrrev_b32 v49, 22, v49
    v_lshl_add_u32 v33, v49, 2, s48
    ds_add_rtn_u32 v41, v33, v5
    v_mad_i32_i24 v9, v49, s46, v9
    v_mul_u32_u24 v50, 21400, v10
    v_lshrrev_b32 v50, 22, v50
    v_lshl_add_u32 v34, v50, 2, s48
    ds_add_rtn_u32 v42, v34, v5
    v_mad_i32_i24 v10, v50, s46, v10
    v_mul_u32_u24 v51, 21400, v11
    v_lshrrev_b32 v51, 22, v51
    v_lshl_add_u32 v35, v51, 2, s48
    ds_add_rtn_u32 v43, v35, v5
    v_mad_i32_i24 v11, v51, s46, v11
    s_mov_b64 exec, s[42:43]
    s_waitcnt lgkmcnt(3)
    v_and_or_b32 v6, v40, 63, s51
    v_mad_u32_u24 v48, v48, s49, v6
    ds_write_b8 v48, v8
    s_waitcnt lgkmcnt(3)
    v_and_or_b32 v7, v41, 63, s51
    v_mad_u32_u24 v49, v49, s49, v7
    ds_write_b8 v49, v9
    s_waitcnt lgkmcnt(3)
    v_and_or_b32 v6, v42, 63, s51
    v_mad_u32_u24 v50, v50, s49, v6
    ds_write_b8 v50, v10
    s_waitcnt lgkmcnt(3)
    v_and_or_b32 v7, v43, 63, s51
    v_mad_u32_u24 v51, v51, s49, v7
    ds_write_b8 v51, v11
    s_mov_b64 exec, -1
    s_waitcnt lgkmcnt(0)
    v_mov_b32 v4, 54420
    v_mov_b32 v6, 1
    s_mov_b64 exec, 1
    ds_add_u32 v4, v6
    s_branch GT_R1
GS_R1:
    s_sleep 1
GT_R1:
    ds_read_b32 v6, v4
    s_waitcnt lgkmcnt(0)
    v_cmp_gt_u32 vcc, 8, v6
    s_cbranch_vccnz GS_R1
    s_mov_b64 exec, -1
    ds_read_b64 v[28:29], v64
    s_waitcnt lgkmcnt(0)
    v_add3_u32 v7, v28, v29, -6
    v_max_u32 v31, v28, v29
    v_mov_b32 v30, v7
    v_cmp_lt_u32 s[52:53], 48, v31
    s_nop 1
    v_add_u32_dpp v30, v30, v30 row_shr:1 row_mask:0xf bank_mask:0xf bound_ctrl:0
    s_nop 1
    v_add_u32_dpp v30, v30, v30 row_shr:2 row_mask:0xf bank_mask:0xf bound_ctrl:0
    s_nop 1
    v_add_u32_dpp v30, v30, v30 row_shr:4 row_mask:0xf bank_mask:0xf bound_ctrl:0
    s_nop 1
    v_add_u32_dpp v30, v30, v30 row_shr:8 row_mask:0xf bank_mask:0xf bound_ctrl:0
    s_nop 1
    v_add_u32_dpp v30, v30, v30 row_bcast:15 row_mask:0xa bank_mask:0xf
    s_nop 1
    v_add_u32_dpp v30, v30, v30 row_bcast:31 row_mask:0xc bank_mask:0xf
    v_sub_u32 v30, v30, v7
    s_mov_b32 s39, 141556
    v_add3_u32 v31, v30, v28, -3
    v_lshl_add_u32 v30, v30, 2, s39
    v_lshl_add_u32 v31, v31, 2, s39
    ds_write_b64 v64, v[30:31] offset:512
    s_mov_b64 exec, s[42:43]
    ds_read_b32 v32, v32 offset:512
    ds_read_b32 v33, v33 offset:512
    ds_read_b32 v34, v34 offset:512
    ds_read_b32 v35, v35 offset:512
    s_mov_b64 exec, -1
    s_cmp_ge_u32 s3, 14
    s_cbranch_scc1 K_ND1
    ds_read2st64_b32 v[6:7], v67 offset0:0 offset1:2
    ds_read_b32 v56, v73
    ds_read_b32 v57, v74
    ds_read_b32 v58, v75
    ds_read_b32 v59, v76
    s_waitcnt lgkmcnt(3)
    v_min_u32 v6, 255, v6
    v_subrev_u32 v7, s39, v7
    v_lshl_or_b32 v6, v7, 8, v6
    v_bfi_b32 v56, v72, v6, v56
K_ND1:
    s_waitcnt lgkmcnt(0)
    v_lshl_add_u32 v32, v40, 2, v32
    v_lshl_add_u32 v33, v41, 2, v33
    v_lshl_add_u32 v34, v42, 2, v34
    v_lshl_add_u32 v35, v43, 2, v35
    s_mov_b64 exec, s[42:43]
    s_waitcnt vmcnt(0)
    v_lshl_or_b32 v16, v24, 16, v16
    ds_write_b32 v32, v16
    v_and_or_b32 v17, v24, s47, v17
    ds_write_b32 v33, v17
    v_lshl_or_b32 v18, v25, 16, v18
    ds_write_b32 v34, v18
    v_and_or_b32 v19, v25, s47, v19
    ds_write_b32 v35, v19
    s_mov_b64 exec, -1
K_COPY:
    s_waitcnt lgkmcnt(0)
    v_mov_b32 v4, 54424
    v_mov_b32 v5, 1
    s_mov_b64 exec, 1
    ds_add_u32 v4, v5
    s_mov_b64 exec, -1
    v_mov_b32 v4, 54424
    s_mov_b64 exec, 1
GS_P:
    ds_read_b32 v5, v4
    s_waitcnt lgkmcnt(0)
    v_cmp_gt_u32 vcc, 8, v5
    s_cbranch_vccnz GS_P
    s_mov_b64 exec, -1
    s_cmp_ge_u32 s3, 14
    s_cbranch_scc1 K_NDS
    buffer_store_dwordx4 v[56:59], v70, s[12:15], s50 offen sc0 sc1
K_NDS:
    v_cmp_gt_u32 vcc, 272, v62
    ds_read_b128 v[8:11], v66
    s_mov_b64 exec, vcc
    ds_read_b128 v[12:15], v66 offset:8192
    s_mov_b64 exec, -1
    s_waitcnt lgkmcnt(1)
    buffer_store_dwordx4 v[8:11], v70, s[12:15], s54 offen sc0 sc1
    s_cbranch_vccz K_NC
    s_mov_b64 exec, vcc
    s_waitcnt lgkmcnt(0)
    buffer_store_dwordx4 v[12:15], v70, s[12:15], s55 offen sc0 sc1
    s_mov_b64 exec, -1
K_NC:
    s_cmp_eq_u64 s[52:53], 0
    s_cbranch_scc1 K_NR
    s_cmp_lt_u32 s3, 14
    s_cbranch_scc1 K_NR
    v_and_b32 v6, 127, v62
    v_mul_u32_u24 v7, 80, v6
    v_add_u32 v7, s51, v7
    v_lshlrev_b32 v6, 4, v6
    ds_read_b128 v[80:83], v7 offset:48
    s_add_u32 s39, s50, 18816
    s_waitcnt lgkmcnt(0)
    buffer_store_dwordx4 v[80:83], v6, s[12:15], s39 offen sc0 sc1
K_NR:
    s_nop 0
K_FILL:
    s_setprio 0
    v_lshlrev_b32 v112, 4, v0
    v_mov_b32 v104, 65280
    v_mov_b32 v105, 65280
    v_mov_b32 v106, 65280
    v_mov_b32 v107, 65280
    ds_write_b128 v112, v[104:107] offset:0
    ds_write_b128 v112, v[104:107] offset:16384
    ds_write_b128 v112, v[104:107] offset:32768
    s_cmp_lt_u32 s3, 4
    s_cbranch_scc1 K2_ZD
    s_cmp_gt_u32 s3, 7
    s_cbranch_scc1 K2_ZD
    s_cmp_lt_u32 s3, 7
    s_cbranch_scc1 K2_Z4
    v_mov_b64 v[108:109], 0
    v_mov_b64 v[110:111], 0
    s_mov_b32 exec_hi, 0
    ds_write_b128 v112, v[108:111] offset:46656
    s_mov_b64 exec, -1
    s_branch K2_ZD
K2_Z4:
    ds_write_b128 v112, v[104:107] offset:45056
K2_ZD:
    v_and_b32 v2, 7, v0
    v_lshlrev_b32 v2, 4, v2
    v_add_u32 v32, 54528, v2
    v_and_b32 v11, 56, v1
    v_add_u32 v11, 52224, v11
    v_lshlrev_b32 v33, 4, v1
    v_lshlrev_b32 v28, 3, v1
    v_and_b32 v28, 16, v28
    v_mov_b32 v29, 0x3f80
    v_lshlrev_b32 v28, v28, v29
    v_bfe_i32 v29, v1, 0, 1
    v_and_b32 v5, v28, v29
    v_sub_u32 v4, v28, v5
    v_mov_b32 v10, 0
    v_mov_b64 v[14:15], 0
    v_mov_b64 v[18:19], 0
    s_waitcnt vmcnt(0)
    s_cmp_lg_u32 s3, 7
    s_cbranch_scc1 K_XB
    s_memrealtime s[52:53]
    s_and_b32 s35, s2, 63
    s_lshl_b32 s35, s35, 7
    s_lshr_b32 s36, s2, 6
    s_lshl3_add_u32 s35, s36, s35
    s_add_u32 s35, s35, 5341184
    s_mov_b32 s36, 8320
    v_mul_u32_u24 v29, s36, v1
    v_add_u32 v29, s35, v29
    s_waitcnt lgkmcnt(0)
    v_mov_b64 v[52:53], s[52:53]
    v_mov_b64 v[54:55], s[52:53]
    s_barrier
    s_bfm_b64 exec, 8, 0
    buffer_store_dwordx2 v[52:53], v29, s[12:15], 0 offen sc0 sc1
    s_mov_b64 exec, -1
    v_lshrrev_b32 v28, 1, v2
    ds_read_b64 v[8:9], v28 offset:54336
    s_mov_b32 s37, 0xffff0000
    s_waitcnt lgkmcnt(0)
    v_lshlrev_b32 v6, 16, v8
    v_and_b32 v7, s37, v8
    v_lshlrev_b32 v8, 16, v9
    v_and_b32 v9, s37, v9
    v_pk_mul_f32 v[6:7], v[6:7], s[40:41]
    v_pk_mul_f32 v[8:9], v[8:9], s[40:41]
    v_lshrrev_b32 v12, 2, v0
    s_movk_i32 s35, 20864
    v_mul_u32_u24 v12, s35, v12
    v_and_b32 v34, 3, v0
    v_mad_u32_u24 v13, v34, 12, v12
    v_lshl_add_u32 v16, v34, 2, v12
    v_lshl_add_u32 v12, v34, 4, v12
    v_lshlrev_b32 v34, 2, v34
    v_mov_b32 v35, 260
    v_mov_b32 v17, 4
    s_movk_i32 s58, 6132
    s_mul_i32 s59, s32, 48
    s_lshl_b32 s61, s32, 4
    s_add_u32 s61, s61, 18816
    s_mov_b32 s56, 0xeeeeeeee
    s_mov_b32 s57, s56
    v_mov_b32 v30, 54400
    s_movk_i32 s38, 128
    s_mov_b32 s100, 0xffff0000
    s_movk_i32 s93, 0x207
    s_mov_b64 s[46:47], 0
    s_mul_i32 s35, s32, 25088
    s_lshl_b32 s36, s33, 6
    s_add_u32 s35, s35, s36
    s_sub_u32 s35, s35, 54528
    v_lshrrev_b32 v127, 1, v2
    v_sub_u32 v127, s35, v127
    s_mov_b32 s96, 0
    s_mov_b32 s94, 0x1f800000
    s_mov_b32 s95, 0x1f800000
    s_mov_b32 s101, 0
    v_mov_b32 v44, 54428
    s_mov_b64 exec, 1
GS_MW:
    s_sleep 2
    ds_read_b32 v45, v44
    s_waitcnt lgkmcnt(0)
    v_cmp_gt_u32 vcc, 7, v45
    s_cbranch_vccnz GS_MW
    s_mov_b64 exec, -1
    s_mov_b32 s35, 32768
    s_and_b32 s36, s2, 7
    s_mul_i32 s36, s36, 8320
    s_add_u32 s36, s36, 5341184
    v_lshlrev_b32 v28, 7, v1
    s_sub_u32 s52, 0, s4
    s_subb_u32 s53, 0, s5
K_POLL:
    buffer_load_dwordx4 v[44:47], v28, s[12:15], s36 offen sc0 sc1
    buffer_load_dwordx4 v[48:51], v28, s[12:15], s36 offen offset:16 sc0 sc1
    s_waitcnt vmcnt(0)
    v_lshl_add_u64 v[44:45], v[44:45], 0, s[52:53]
    v_lshl_add_u64 v[46:47], v[46:47], 0, s[52:53]
    v_lshl_add_u64 v[48:49], v[48:49], 0, s[52:53]
    v_lshl_add_u64 v[50:51], v[50:51], 0, s[52:53]
    v_or3_b32 v44, v44, v46, v48
    v_or3_b32 v45, v45, v47, v49
    v_or_b32 v44, v44, v50
    v_lshrrev_b32 v44, 26, v44
    v_or3_b32 v44, v44, v45, v51
    v_cmp_ne_u32 vcc, 0, v44
    s_and_b64 exec, exec, vcc
    s_cbranch_scc0 K_GOT
    s_sleep 1
    s_sub_u32 s35, s35, 1
    s_cmp_lg_u32 s35, 0
    s_cbranch_scc1 K_POLL
K_GOT:
    s_mov_b64 exec, -1
    v_mov_b32 v28, 54400
    v_mov_b32 v29, s35
    ds_write_b32 v28, v29
    s_waitcnt lgkmcnt(0)
    s_branch K_Y
K_XB:
    s_cmp_ge_u32 s3, 8
    s_cbranch_scc1 K_XP
    s_waitcnt lgkmcnt(0)
    s_barrier
    s_mov_b32 m0, s53
    s_sub_u32 s55, 7, s33
    s_cmp_ge_u32 s3, s55
    s_cbranch_scc1 K_B3T
    buffer_load_dwordx4 v124, s[8:11], 0 offen lds
    s_cmp_eq_u32 s3, 6
    s_cbranch_scc1 K_B3T
    buffer_load_dwordx4 v125, s[8:11], 0 offen offset:1024 lds
K_B3T:
    v_lshrrev_b32 v28, 1, v2
    ds_read_b64 v[8:9], v28 offset:54336
    s_mov_b32 s37, 0xffff0000
    s_waitcnt lgkmcnt(0)
    v_lshlrev_b32 v6, 16, v8
    v_and_b32 v7, s37, v8
    v_lshlrev_b32 v8, 16, v9
    v_and_b32 v9, s37, v9
    v_pk_mul_f32 v[6:7], v[6:7], s[40:41]
    v_pk_mul_f32 v[8:9], v[8:9], s[40:41]
    v_lshrrev_b32 v12, 2, v0
    s_movk_i32 s35, 20864
    v_mul_u32_u24 v12, s35, v12
    v_and_b32 v34, 3, v0
    v_mad_u32_u24 v13, v34, 12, v12
    v_lshl_add_u32 v16, v34, 2, v12
    v_lshl_add_u32 v12, v34, 4, v12
    v_lshlrev_b32 v34, 2, v34
    v_mov_b32 v35, 260
    v_mov_b32 v17, 4
    s_movk_i32 s58, 6132
    s_mul_i32 s59, s32, 48
    s_lshl_b32 s61, s32, 4
    s_add_u32 s61, s61, 18816
    s_mov_b32 s56, 0xeeeeeeee
    s_mov_b32 s57, s56
    v_mov_b32 v30, 54400
    s_movk_i32 s38, 128
    s_mov_b32 s100, 0xffff0000
    s_movk_i32 s93, 0x207
    s_mov_b64 s[46:47], 0
    s_mul_i32 s35, s32, 25088
    s_lshl_b32 s36, s33, 6
    s_add_u32 s35, s35, s36
    s_sub_u32 s35, s35, 54528
    v_lshrrev_b32 v127, 1, v2
    v_sub_u32 v127, s35, v127
    s_mov_b32 s96, 0
    s_mov_b32 s94, 0x1f800000
    s_mov_b32 s95, 0x1f800000
    s_mov_b32 s101, 0
    s_waitcnt vmcnt(0)
    v_mov_b32 v44, 54428
    v_mov_b32 v45, 1
    s_mov_b64 exec, 1
    ds_add_u32 v44, v45
    s_mov_b64 exec, -1
    s_branch K_PD
K_XP:
    s_barrier
    s_sub_u32 s3, s3, 9
    s_lshl_b32 s36, s3, 12
    s_add_u32 s37, s36, 80128
    v_and_b32 v29, 31, v1
    v_lshl_add_u32 v29, v29, 7, s37
    v_bfe_u32 v30, v1, 1, 3
    v_lshrrev_b32 v120, 5, v1
    v_xor_b32 v30, v30, v120
    v_lshl_add_u32 v36, v30, 4, v29
    v_xor_b32 v37, 32, v36
    v_xor_b32 v38, 64, v36
    v_xor_b32 v39, 96, v36
    v_lshlrev_b32 v120, 9, v120
    v_bfe_u32 v29, v1, 2, 2
    v_lshl_add_u32 v120, v29, 6, v120
    v_bfe_u32 v29, v1, 4, 1
    v_lshl_add_u32 v120, v29, 5, v120
    v_and_b32 v29, 3, v1
    v_lshl_add_u32 v120, v29, 3, v120
    v_add_u32 v120, 105728, v120
    v_lshrrev_b32 v123, 5, v1
    v_lshlrev_b32 v123, 9, v123
    v_and_b32 v30, 31, v1
    v_lshl_add_u32 v123, v30, 2, v123
    v_add_u32 v123, s36, v123
    s_add_u32 s3, s3, 9
    v_lshrrev_b32 v28, 1, v2
    ds_read_b64 v[8:9], v28 offset:54336
    s_mov_b32 s37, 0xffff0000
    s_waitcnt lgkmcnt(0)
    v_lshlrev_b32 v6, 16, v8
    v_and_b32 v7, s37, v8
    v_lshlrev_b32 v8, 16, v9
    v_and_b32 v9, s37, v9
    v_pk_mul_f32 v[6:7], v[6:7], s[40:41]
    v_pk_mul_f32 v[8:9], v[8:9], s[40:41]
    v_lshrrev_b32 v12, 2, v0
    s_movk_i32 s35, 20864
    v_mul_u32_u24 v12, s35, v12
    v_and_b32 v34, 3, v0
    v_mad_u32_u24 v13, v34, 12, v12
    v_lshl_add_u32 v16, v34, 2, v12
    v_lshl_add_u32 v12, v34, 4, v12
    v_lshlrev_b32 v34, 2, v34
    v_mov_b32 v35, 260
    v_mov_b32 v17, 4
    s_movk_i32 s58, 6132
    s_mul_i32 s59, s32, 48
    s_lshl_b32 s61, s32, 4
    s_add_u32 s61, s61, 18816
    s_mov_b32 s56, 0xeeeeeeee
    s_mov_b32 s57, s56
    v_mov_b32 v30, 54400
    s_movk_i32 s38, 128
    s_mov_b32 s100, 0xffff0000
    s_movk_i32 s93, 0x207
    s_mov_b64 s[46:47], 0
    s_mul_i32 s35, s32, 25088
    s_lshl_b32 s36, s33, 6
    s_add_u32 s35, s35, s36
    s_sub_u32 s35, s35, 54528
    v_lshrrev_b32 v127, 1, v2
    v_sub_u32 v127, s35, v127
    s_mov_b32 s96, 0
    s_mov_b32 s94, 0x1f800000
    s_mov_b32 s95, 0x1f800000
    s_mov_b32 s101, 0
    s_cmp_lg_u32 s3, 8
    s_cbranch_scc1 K_PP
    v_mov_b32 v44, 54428
    s_mov_b64 exec, 1
GS_P8:
    s_sleep 1
    ds_read_b32 v45, v44
    s_waitcnt lgkmcnt(0)
    v_cmp_gt_u32 vcc, 7, v45
    s_cbranch_vccnz GS_P8
    s_mov_b64 exec, -1
    s_mul_i32 s35, s32, 196
    s_mul_i32 s36, s33, 96
    s_add_u32 s35, s35, s36
    v_add_u32 v44, s35, v1
    v_add_u32 v45, 64, v44
    buffer_load_dword v126, v44, s[24:27], 0 idxen sc0 sc1
    s_mov_b32 exec_hi, 0
    buffer_load_dword v126, v45, s[24:27], 0 idxen sc0 sc1
    s_mov_b64 exec, -1
    s_branch K_PD
K_PP:
    ds_read_b64_tr_b16 v[56:57], v120 offset:16384
    ds_read_b64_tr_b16 v[58:59], v120 offset:16640
    ds_read_b64_tr_b16 v[60:61], v120 offset:17408
    ds_read_b64_tr_b16 v[62:63], v120 offset:17664
    ds_read_b64_tr_b16 v[64:65], v120 offset:18432
    ds_read_b64_tr_b16 v[66:67], v120 offset:18688
    ds_read_b64_tr_b16 v[68:69], v120 offset:19456
    ds_read_b64_tr_b16 v[70:71], v120 offset:19712
    s_waitcnt lgkmcnt(0)
    ds_read_b64_tr_b16 v[72:73], v120 offset:20480
    ds_read_b64_tr_b16 v[74:75], v120 offset:20736
    ds_read_b64_tr_b16 v[76:77], v120 offset:21504
    ds_read_b64_tr_b16 v[78:79], v120 offset:21760
    ds_read_b64_tr_b16 v[80:81], v120 offset:22528
    ds_read_b64_tr_b16 v[82:83], v120 offset:22784
    ds_read_b64_tr_b16 v[84:85], v120 offset:23552
    ds_read_b64_tr_b16 v[86:87], v120 offset:23808
    s_waitcnt lgkmcnt(0)
    v_mov_b32 v44, 54428
    s_mov_b64 exec, 1
GS_P2:
    s_sleep 1
    ds_read_b32 v45, v44
    s_waitcnt lgkmcnt(0)
    v_cmp_gt_u32 vcc, 7, v45
    s_cbranch_vccnz GS_P2
    s_mov_b64 exec, -1
    ds_read_b128 v[40:43], v36
    ds_read_b128 v[44:47], v37
    ds_read_b128 v[48:51], v38
    ds_read_b128 v[52:55], v39
    s_waitcnt lgkmcnt(3)
    v_mfma_f32_32x32x16_bf16 v[88:103], v[40:43], v[56:59], 0
    v_mfma_f32_32x32x16_bf16 v[104:119], v[40:43], v[72:75], 0
    s_waitcnt lgkmcnt(2)
    v_mfma_f32_32x32x16_bf16 v[88:103], v[44:47], v[60:63], v[88:103]
    v_mfma_f32_32x32x16_bf16 v[104:119], v[44:47], v[76:79], v[104:119]
    s_waitcnt lgkmcnt(1)
    v_mfma_f32_32x32x16_bf16 v[88:103], v[48:51], v[64:67], v[88:103]
    v_mfma_f32_32x32x16_bf16 v[104:119], v[48:51], v[80:83], v[104:119]
    s_waitcnt lgkmcnt(0)
    v_mfma_f32_32x32x16_bf16 v[88:103], v[52:55], v[68:71], v[88:103]
    v_mfma_f32_32x32x16_bf16 v[104:119], v[52:55], v[84:87], v[104:119]
    s_cmp_eq_u32 s3, 15
    s_nop 9
    v_pk_mul_f32 v[88:89], v[88:89], s[40:41]
    v_pk_mul_f32 v[90:91], v[90:91], s[40:41]
    v_cvt_pk_bf16_f32 v88, v88, v104
    ds_write_b32 v123, v88 offset:54528
    v_cvt_pk_bf16_f32 v89, v89, v105
    ds_write_b32 v123, v89 offset:54656
    v_cvt_pk_bf16_f32 v90, v90, v106
    ds_write_b32 v123, v90 offset:54784
    v_cvt_pk_bf16_f32 v91, v91, v107
    ds_write_b32 v123, v91 offset:54912
    s_cbranch_scc1 K_PD
    v_pk_mul_f32 v[92:93], v[92:93], s[40:41]
    v_pk_mul_f32 v[94:95], v[94:95], s[40:41]
    v_cvt_pk_bf16_f32 v92, v92, v108
    ds_write_b32 v123, v92 offset:55552
    v_cvt_pk_bf16_f32 v93, v93, v109
    ds_write_b32 v123, v93 offset:55680
    v_cvt_pk_bf16_f32 v94, v94, v110
    ds_write_b32 v123, v94 offset:55808
    v_cvt_pk_bf16_f32 v95, v95, v111
    ds_write_b32 v123, v95 offset:55936
    v_pk_mul_f32 v[96:97], v[96:97], s[40:41]
    v_pk_mul_f32 v[98:99], v[98:99], s[40:41]
    v_cvt_pk_bf16_f32 v96, v96, v112
    ds_write_b32 v123, v96 offset:56576
    v_cvt_pk_bf16_f32 v97, v97, v113
    ds_write_b32 v123, v97 offset:56704
    v_cvt_pk_bf16_f32 v98, v98, v114
    ds_write_b32 v123, v98 offset:56832
    v_cvt_pk_bf16_f32 v99, v99, v115
    ds_write_b32 v123, v99 offset:56960
    v_pk_mul_f32 v[100:101], v[100:101], s[40:41]
    v_pk_mul_f32 v[102:103], v[102:103], s[40:41]
    s_waitcnt lgkmcnt(4)
    v_cvt_pk_bf16_f32 v100, v100, v116
    ds_write_b32 v123, v100 offset:57600
    v_cvt_pk_bf16_f32 v101, v101, v117
    ds_write_b32 v123, v101 offset:57728
    v_cvt_pk_bf16_f32 v102, v102, v118
    ds_write_b32 v123, v102 offset:57856
    v_cvt_pk_bf16_f32 v103, v103, v119
    ds_write_b32 v123, v103 offset:57984
K_PD:
    s_waitcnt lgkmcnt(0)
K_Y:
    s_barrier
    buffer_load_dwordx3 v[42:44], v13, s[12:15], s59 offen sc0 sc1
    ds_read_b32 v30, v30
    s_barrier
    s_lshr_b32 s35, s2, 3
    s_mul_i32 s35, s35, 782
    s_mul_i32 s36, s3, 3
    s_add_u32 s35, s35, s36
    s_add_u32 s35, s35, 128
    v_add_u32 v28, s35, v1
    s_bfm_b64 exec, 3, 0
    buffer_load_dword v126, v28, s[24:27], 0 idxen sc0 sc1
    s_mov_b64 exec, -1
    s_waitcnt lgkmcnt(0)
    v_cmp_eq_u32 vcc, 0, v30
    s_cbranch_vccnz K_ALONE
    s_waitcnt vmcnt(1)
K_RANK:
    v_mov_b32_dpp v41, v42 quad_perm:[0,0,0,0] row_mask:0xf bank_mask:0xf
    v_sub_u32_sdwa v40, v41, v34 dst_sel:DWORD dst_unused:UNUSED_PAD src0_sel:BYTE_0 src1_sel:DWORD
    v_bfe_u32 v41, v41, 8, 16
    v_cmp_lt_i32 vcc, 0, v40
    v_cmp_lt_i32 s[48:49], 16, v40
    v_add_u32 v12, v12, v41
    v_mul_u32_u24_sdwa v56, v42, v35 dst_sel:DWORD dst_unused:UNUSED_PAD src0_sel:BYTE_0 src1_sel:DWORD
    v_mul_u32_u24_sdwa v57, v42, v35 dst_sel:DWORD dst_unused:UNUSED_PAD src0_sel:BYTE_1 src1_sel:DWORD
    v_mul_u32_u24_sdwa v58, v42, v35 dst_sel:DWORD dst_unused:UNUSED_PAD src0_sel:BYTE_2 src1_sel:DWORD
    v_mul_u32_u24_sdwa v59, v42, v35 dst_sel:DWORD dst_unused:UNUSED_PAD src0_sel:BYTE_3 src1_sel:DWORD
    v_mul_u32_u24_sdwa v60, v43, v35 dst_sel:DWORD dst_unused:UNUSED_PAD src0_sel:BYTE_0 src1_sel:DWORD
    v_mul_u32_u24_sdwa v61, v43, v35 dst_sel:DWORD dst_unused:UNUSED_PAD src0_sel:BYTE_1 src1_sel:DWORD
    v_mul_u32_u24_sdwa v62, v43, v35 dst_sel:DWORD dst_unused:UNUSED_PAD src0_sel:BYTE_2 src1_sel:DWORD
    v_mul_u32_u24_sdwa v63, v43, v35 dst_sel:DWORD dst_unused:UNUSED_PAD src0_sel:BYTE_3 src1_sel:DWORD
    s_mov_b64 exec, s[56:57]
    v_cmpx_lt_i32 s[64:65], 0, v40
    ds_add_rtn_u32 v112, v56, v17 offset:32
    v_cmpx_lt_i32 s[66:67], 1, v40
    ds_add_rtn_u32 v113, v57, v17 offset:32
    v_cmpx_lt_i32 s[68:69], 2, v40
    ds_add_rtn_u32 v114, v58, v17 offset:32
    s_mov_b64 exec, -1
    v_cmpx_lt_i32 s[70:71], 3, v40
    ds_add_rtn_u32 v115, v59, v17 offset:32
    v_cmpx_lt_i32 s[72:73], 16, v40
    ds_add_rtn_u32 v116, v60, v17 offset:32
    v_cmpx_lt_i32 s[74:75], 17, v40
    ds_add_rtn_u32 v117, v61, v17 offset:32
    v_cmpx_lt_i32 s[76:77], 18, v40
    ds_add_rtn_u32 v118, v62, v17 offset:32
    v_cmpx_lt_i32 s[78:79], 19, v40
    ds_add_rtn_u32 v119, v63, v17 offset:32
    s_mov_b64 exec, -1
    v_cmp_lt_i32 s[62:63], 32, v40
    s_cmp_lg_u64 s[62:63], 0
    s_cbranch_scc0 K2_NOB
    v_cmp_lt_i32 vcc, 48, v40
    s_cbranch_vccz K2_NOC
    s_mov_b64 exec, vcc
    buffer_load_dword v45, v16, s[12:15], s61 offen sc0 sc1
    buffer_load_dwordx4 v[48:51], v12, s[12:15], s58 offen offset:192 sc0 sc1
    v_cmp_lt_i32 vcc, 64, v40
    v_mov_b32 v28, 53888
    s_waitcnt vmcnt(0) lgkmcnt(0)
    v_mul_u32_u24_sdwa v64, v45, v35 dst_sel:DWORD dst_unused:UNUSED_PAD src0_sel:BYTE_0 src1_sel:DWORD
    v_mul_u32_u24_sdwa v65, v45, v35 dst_sel:DWORD dst_unused:UNUSED_PAD src0_sel:BYTE_1 src1_sel:DWORD
    v_mul_u32_u24_sdwa v66, v45, v35 dst_sel:DWORD dst_unused:UNUSED_PAD src0_sel:BYTE_2 src1_sel:DWORD
    v_mul_u32_u24_sdwa v67, v45, v35 dst_sel:DWORD dst_unused:UNUSED_PAD src0_sel:BYTE_3 src1_sel:DWORD
    v_cmpx_lt_i32 s[62:63], 48, v40
    ds_add_rtn_u32 v24, v64, v17 offset:32
    v_cmpx_lt_i32 s[50:51], 49, v40
    ds_add_rtn_u32 v25, v65, v17 offset:32
    v_cmpx_lt_i32 s[52:53], 50, v40
    ds_add_rtn_u32 v26, v66, v17 offset:32
    v_cmpx_lt_i32 s[54:55], 51, v40
    ds_add_rtn_u32 v27, v67, v17 offset:32
    s_mov_b64 exec, -1
    s_waitcnt lgkmcnt(0)
    v_add_u32_sdwa v24, v24, v64 dst_sel:DWORD dst_unused:UNUSED_PAD src0_sel:BYTE_0 src1_sel:DWORD
    v_add_u32_sdwa v25, v25, v65 dst_sel:DWORD dst_unused:UNUSED_PAD src0_sel:BYTE_0 src1_sel:DWORD
    v_add_u32_sdwa v26, v26, v66 dst_sel:DWORD dst_unused:UNUSED_PAD src0_sel:BYTE_0 src1_sel:DWORD
    v_add_u32_sdwa v27, v27, v67 dst_sel:DWORD dst_unused:UNUSED_PAD src0_sel:BYTE_0 src1_sel:DWORD
    s_mov_b64 exec, s[62:63]
    ds_write_b32 v24, v48 offset:36
    s_mov_b64 exec, s[50:51]
    ds_write_b32 v25, v49 offset:36
    s_mov_b64 exec, s[52:53]
    ds_write_b32 v26, v50 offset:36
    s_mov_b64 exec, s[54:55]
    ds_write_b32 v27, v51 offset:36
    s_mov_b64 exec, vcc
    ds_write_b32 v28, v17
    s_mov_b64 exec, -1
    s_waitcnt lgkmcnt(0)
K2_NOC:
    v_mul_u32_u24_sdwa v64, v44, v35 dst_sel:DWORD dst_unused:UNUSED_PAD src0_sel:BYTE_0 src1_sel:DWORD
    v_mul_u32_u24_sdwa v65, v44, v35 dst_sel:DWORD dst_unused:UNUSED_PAD src0_sel:BYTE_1 src1_sel:DWORD
    v_mul_u32_u24_sdwa v66, v44, v35 dst_sel:DWORD dst_unused:UNUSED_PAD src0_sel:BYTE_2 src1_sel:DWORD
    v_mul_u32_u24_sdwa v67, v44, v35 dst_sel:DWORD dst_unused:UNUSED_PAD src0_sel:BYTE_3 src1_sel:DWORD
    v_cmpx_lt_i32 s[62:63], 32, v40
    ds_add_rtn_u32 v24, v64, v17 offset:32
    v_cmpx_lt_i32 s[50:51], 33, v40
    ds_add_rtn_u32 v25, v65, v17 offset:32
    v_cmpx_lt_i32 s[52:53], 34, v40
    ds_add_rtn_u32 v26, v66, v17 offset:32
    v_cmpx_lt_i32 s[54:55], 35, v40
    ds_add_rtn_u32 v27, v67, v17 offset:32
    s_mov_b64 exec, -1
K2_NOB:
    v_mov_b32 v28, 54272
    v_mov_b32 v29, 1
    s_mov_b64 exec, 1
    ds_add_u32 v28, v29
    s_mov_b64 exec, -1
    v_cmp_lt_i32 vcc, 0, v40
    s_mov_b64 exec, vcc
    buffer_load_dwordx4 v[104:107], v12, s[12:15], s58 offen sc0 sc1
    s_mov_b64 exec, s[48:49]
    buffer_load_dwordx4 v[108:111], v12, s[12:15], s58 offen offset:64 sc0 sc1
    s_mov_b64 exec, -1
    s_cmp_lg_u64 s[62:63], 0
    s_cbranch_scc0 K2_NB2A
    s_mov_b64 exec, s[62:63]
    buffer_load_dwordx4 v[20:23], v12, s[12:15], s58 offen offset:128 sc0 sc1
    s_mov_b64 exec, -1
    s_waitcnt lgkmcnt(1)
    v_add_u32_sdwa v24, v24, v64 dst_sel:DWORD dst_unused:UNUSED_PAD src0_sel:BYTE_0 src1_sel:DWORD
    v_add_u32_sdwa v25, v25, v65 dst_sel:DWORD dst_unused:UNUSED_PAD src0_sel:BYTE_0 src1_sel:DWORD
    v_add_u32_sdwa v26, v26, v66 dst_sel:DWORD dst_unused:UNUSED_PAD src0_sel:BYTE_0 src1_sel:DWORD
    v_add_u32_sdwa v27, v27, v67 dst_sel:DWORD dst_unused:UNUSED_PAD src0_sel:BYTE_0 src1_sel:DWORD
K2_NB2A:
    s_waitcnt lgkmcnt(1)
    v_add_u32_sdwa v112, v112, v56 dst_sel:DWORD dst_unused:UNUSED_PAD src0_sel:BYTE_0 src1_sel:DWORD
    v_add_u32_sdwa v113, v113, v57 dst_sel:DWORD dst_unused:UNUSED_PAD src0_sel:BYTE_0 src1_sel:DWORD
    v_add_u32_sdwa v114, v114, v58 dst_sel:DWORD dst_unused:UNUSED_PAD src0_sel:BYTE_0 src1_sel:DWORD
    v_add_u32_sdwa v115, v115, v59 dst_sel:DWORD dst_unused:UNUSED_PAD src0_sel:BYTE_0 src1_sel:DWORD
    v_add_u32_sdwa v116, v116, v60 dst_sel:DWORD dst_unused:UNUSED_PAD src0_sel:BYTE_0 src1_sel:DWORD
    v_add_u32_sdwa v117, v117, v61 dst_sel:DWORD dst_unused:UNUSED_PAD src0_sel:BYTE_0 src1_sel:DWORD
    v_add_u32_sdwa v118, v118, v62 dst_sel:DWORD dst_unused:UNUSED_PAD src0_sel:BYTE_0 src1_sel:DWORD
    v_add_u32_sdwa v119, v119, v63 dst_sel:DWORD dst_unused:UNUSED_PAD src0_sel:BYTE_0 src1_sel:DWORD
    s_cmp_eq_u32 s3, 0
    s_cbranch_scc1 K2_SORT
    s_cmp_gt_u32 s3, 4
    s_cbranch_scc1 K2_C
    s_cmp_lg_u64 s[62:63], 0
    s_waitcnt vmcnt(2)
    s_cbranch_scc1 K2_PAE
    s_waitcnt vmcnt(1)
K2_PAE:
    s_mov_b64 exec, s[64:65]
    ds_write_b32 v112, v104 offset:36
    s_mov_b64 exec, s[66:67]
    ds_write_b32 v113, v105 offset:36
    s_mov_b64 exec, s[68:69]
    ds_write_b32 v114, v106 offset:36
    s_mov_b64 exec, s[70:71]
    ds_write_b32 v115, v107 offset:36
    s_waitcnt vmcnt(1)
    s_cbranch_scc1 K2_PBE
    s_waitcnt vmcnt(0)
K2_PBE:
    s_mov_b64 exec, s[72:73]
    ds_write_b32 v116, v108 offset:36
    s_mov_b64 exec, s[74:75]
    ds_write_b32 v117, v109 offset:36
    s_mov_b64 exec, s[76:77]
    ds_write_b32 v118, v110 offset:36
    s_mov_b64 exec, s[78:79]
    ds_write_b32 v119, v111 offset:36
    s_mov_b64 exec, -1
    s_branch K2_C
K2_SORT:
    v_mul_u32_u24 v40, 260, v1
    v_add_u32 v40, 32, v40
    v_add_u32 v72, 0, v40
    v_lshlrev_b32 v73, 7, v1
    v_add_u32 v74, 16640, v40
    v_lshlrev_b32 v75, 7, v1
    v_add_u32 v75, 8192, v75
    v_add_u32 v76, 33280, v40
    v_lshlrev_b32 v77, 7, v1
    v_add_u32 v77, 16384, v77
    v_add_u32 v78, 49920, v40
    v_lshlrev_b32 v79, 7, v1
    v_add_u32 v79, 24576, v79
    v_lshlrev_b32 v41, 2, v1
    v_mov_b32 v42, 8
    v_mov_b32 v28, 53888
    s_setprio 3
    v_mov_b32 v46, 54272
    s_mov_b64 exec, 1
GS_SA:
    ds_read_b32 v47, v46
    s_waitcnt lgkmcnt(0)
    v_cmp_gt_u32 vcc, 16, v47
    s_cbranch_vccnz GS_SA
    s_mov_b64 exec, -1
    v_mov_b32 v47, 65280
    ds_read_b32 v44, v40 offset:0
    ds_read_b32 v45, v40 offset:16640
    ds_read_b32 v46, v40 offset:33280
    s_mov_b64 exec, 0xff
    ds_read_b32 v47, v40 offset:49920
    s_mov_b64 exec, -1
    s_waitcnt lgkmcnt(3)
    v_subrev_u32 v44, 65276, v44
    v_lshrrev_b32 v44, 3, v44
    v_min_u32 v48, 32, v44
    v_sub_u32 v48, 32, v48
    v_lshlrev_b32 v48, 2, v48
    ds_add_rtn_u32 v52, v48, v42 offset:53952
    s_waitcnt lgkmcnt(3)
    v_subrev_u32 v45, 65276, v45
    v_lshrrev_b32 v45, 3, v45
    v_min_u32 v49, 32, v45
    v_sub_u32 v49, 32, v49
    v_lshlrev_b32 v49, 2, v49
    ds_add_rtn_u32 v53, v49, v42 offset:53952
    s_waitcnt lgkmcnt(3)
    v_subrev_u32 v46, 65276, v46
    v_lshrrev_b32 v46, 3, v46
    v_min_u32 v50, 32, v46
    v_sub_u32 v50, 32, v50
    v_lshlrev_b32 v50, 2, v50
    ds_add_rtn_u32 v54, v50, v42 offset:53952
    s_waitcnt lgkmcnt(3)
    v_subrev_u32 v47, 65276, v47
    v_lshrrev_b32 v47, 3, v47
    v_min_u32 v51, 32, v47
    v_sub_u32 v51, 32, v51
    v_lshlrev_b32 v51, 2, v51
    s_mov_b64 exec, 0xff
    ds_add_rtn_u32 v55, v51, v42 offset:53952
    s_mov_b64 exec, -1
    ds_read_b32 v41, v41 offset:53952
    v_max3_u32 v40, v44, v45, v46
    v_max_u32 v40, v40, v47
    v_cmp_lt_u32 vcc, 32, v40
    v_lshl_or_b32 v72, v44, 16, v72
    v_lshl_or_b32 v74, v45, 16, v74
    v_lshl_or_b32 v76, v46, 16, v76
    v_lshl_or_b32 v78, v47, 16, v78
    s_waitcnt lgkmcnt(0)
    v_mov_b32 v42, v41
    s_nop 1
    v_add_u32_dpp v42, v42, v42 row_shr:1 row_mask:0xf bank_mask:0xf bound_ctrl:0
    s_nop 1
    v_add_u32_dpp v42, v42, v42 row_shr:2 row_mask:0xf bank_mask:0xf bound_ctrl:0
    s_nop 1
    v_add_u32_dpp v42, v42, v42 row_shr:4 row_mask:0xf bank_mask:0xf bound_ctrl:0
    s_nop 1
    v_add_u32_dpp v42, v42, v42 row_shr:8 row_mask:0xf bank_mask:0xf bound_ctrl:0
    s_nop 1
    v_add_u32_dpp v42, v42, v42 row_bcast:15 row_mask:0xa bank_mask:0xf
    s_nop 1
    v_add_u32_dpp v42, v42, v42 row_bcast:31 row_mask:0xc bank_mask:0xf
    v_sub_u32 v42, v42, v41
    ds_bpermute_b32 v48, v48, v42
    ds_bpermute_b32 v49, v49, v42
    ds_bpermute_b32 v50, v50, v42
    ds_bpermute_b32 v51, v51, v42
    s_waitcnt lgkmcnt(3)
    v_add_u32 v48, v48, v52
    ds_write_b64 v48, v[72:73] offset:52224
    s_waitcnt lgkmcnt(3)
    v_add_u32 v49, v49, v53
    ds_write_b64 v49, v[74:75] offset:52224
    s_waitcnt lgkmcnt(3)
    v_add_u32 v50, v50, v54
    ds_write_b64 v50, v[76:77] offset:52224
    s_waitcnt lgkmcnt(3)
    v_add_u32 v51, v51, v55
    s_mov_b64 exec, 0xff
    ds_write_b64 v51, v[78:79] offset:52224
    s_mov_b64 exec, vcc
    ds_write_b32 v28, v28
    s_mov_b64 exec, -1
K2_C:
    v_lshlrev_b32 v30, 6, v1
    v_mov_b32 v31, 53888
    v_mov_b32 v35, 0
    s_waitcnt lgkmcnt(0)
    s_barrier
    s_lshr_b32 s35, s2, 3
    s_mul_i32 s35, s35, 782
    s_mul_i32 s36, s3, 8
    s_add_u32 s35, s35, s36
    v_add_u32 v28, s35, v1
    s_bfm_b64 exec, 8, 0
    buffer_load_dword v126, v28, s[24:27], 0 idxen sc0 sc1
    s_mov_b64 exec, -1
    ds_read_b32 v28, v31
    s_mov_b64 exec, 0x1ffffff
    ds_read_u16 v35, v30 offset:52226
    s_mov_b64 exec, -1
    s_setprio 0
    s_waitcnt lgkmcnt(0)
    v_readfirstlane_b32 s35, v28
    v_mov_b32 v34, v35
    s_or_b32 s35, s35, s34
    s_cbranch_scc1 K2_RESTART
    s_nop 1
    v_add_u32_dpp v34, v34, v34 row_shr:1 row_mask:0xf bank_mask:0xf bound_ctrl:0
    s_nop 1
    v_add_u32_dpp v34, v34, v34 row_shr:2 row_mask:0xf bank_mask:0xf bound_ctrl:0
    s_nop 1
    v_add_u32_dpp v34, v34, v34 row_shr:4 row_mask:0xf bank_mask:0xf bound_ctrl:0
    s_nop 1
    v_add_u32_dpp v34, v34, v34 row_shr:8 row_mask:0xf bank_mask:0xf bound_ctrl:0
    s_nop 1
    v_add_u32_dpp v34, v34, v34 row_bcast:15 row_mask:0xa bank_mask:0xf
    s_nop 0
    v_readlane_b32 s35, v34, 31
    v_sub_u32 v34, v34, v35
    s_mov_b32 s39, s35
    s_mul_i32 s36, s3, s39
    s_add_u32 s45, s36, s39
    s_lshr_b32 s36, s36, 4
    s_lshr_b32 s45, s45, 4
    v_cmp_ge_u32 vcc, s36, v34
    s_sub_u32 s45, s45, s36
    s_bcnt1_i32_b32 s43, vcc_lo
    s_sub_u32 s43, s43, 1
    s_min_u32 s43, s43, 24
    v_readlane_b32 s44, v34, s43
    s_sub_u32 s44, s36, s44
    s_lshl_b32 s35, s43, 6
    v_add_u32 v28, s35, v11
    ds_read_b64 v[30:31], v28
    ds_read_b64 v[124:125], v28 offset:64
    v_readlane_b32 s42, v35, s43
    s_lshl_b32 s35, s44, 3
    s_sub_u32 s42, s42, s44
    s_min_u32 s42, s42, s45
    s_sub_u32 s45, s45, s42
    s_mov_b32 s56, s43
    s_mov_b32 s57, s42
    s_mov_b32 s58, s45
    s_waitcnt lgkmcnt(1)
    v_add_u32_sdwa v3, v30, s35 dst_sel:DWORD dst_unused:UNUSED_PAD src0_sel:WORD_0 src1_sel:DWORD
    v_add_u32 v30, v31, v32
    s_sub_u32 s35, s3, 1
    s_cmp_lt_u32 s35, 4
    s_cbranch_scc1 K2_D
    s_cmp_lg_u64 s[62:63], 0
    s_waitcnt vmcnt(3)
    s_cbranch_scc1 K2_PAL
    s_waitcnt vmcnt(2)
K2_PAL:
    s_mov_b64 exec, s[64:65]
    ds_write_b32 v112, v104 offset:36
    s_mov_b64 exec, s[66:67]
    ds_write_b32 v113, v105 offset:36
    s_mov_b64 exec, s[68:69]
    ds_write_b32 v114, v106 offset:36
    s_mov_b64 exec, s[70:71]
    ds_write_b32 v115, v107 offset:36
    s_waitcnt vmcnt(2)
    s_cbranch_scc1 K2_PBL
    s_waitcnt vmcnt(1)
K2_PBL:
    s_mov_b64 exec, s[72:73]
    ds_write_b32 v116, v108 offset:36
    s_mov_b64 exec, s[74:75]
    ds_write_b32 v117, v109 offset:36
    s_mov_b64 exec, s[76:77]
    ds_write_b32 v118, v110 offset:36
    s_mov_b64 exec, s[78:79]
    ds_write_b32 v119, v111 offset:36
    s_mov_b64 exec, -1
K2_D:
    s_cmp_lg_u64 s[62:63], 0
    s_cbranch_scc0 K2_PN
    s_waitcnt vmcnt(1)
    s_mov_b64 exec, s[62:63]
    ds_write_b32 v24, v20 offset:36
    s_mov_b64 exec, s[50:51]
    ds_write_b32 v25, v21 offset:36
    s_mov_b64 exec, s[52:53]
    ds_write_b32 v26, v22 offset:36
    s_mov_b64 exec, s[54:55]
    ds_write_b32 v27, v23 offset:36
    s_mov_b64 exec, -1
K2_PN:
    v_mov_b32 v37, v2
    v_mov_b32 v39, v2
    s_waitcnt lgkmcnt(0)
    v_mov_b64 v[104:105], 0
    v_mov_b64 v[106:107], 0
    v_mov_b64 v[108:109], 0
    v_mov_b64 v[110:111], 0
    s_barrier
    v_readlane_b32 s61, v35, 24
    s_cmp_eq_u32 s42, 0
    s_cbranch_scc1 K2_LOOPDONE
    ds_read_b128 v[120:123], v30
    s_sub_u32 s57, s57, 1
    s_cbranch_scc1 K2_LSWFA0
K2_LSRFA0:
    ds_read_u16 v36, v3 offset:4
    ds_read_u16 v38, v3 offset:8
    ds_read_u16_d16_hi v104, v3 offset:6
    ds_read_u16_d16_hi v105, v3 offset:10
    s_cmp_lg_u32 s96, 0
    s_cbranch_scc1 K2_FS0
    s_waitcnt lgkmcnt(2)
    buffer_load_dwordx4 v[72:75], v[36:37], s[24:27], 0 idxen offen sc0 sc1
    buffer_load_dwordx4 v[76:79], v[38:39], s[24:27], 0 idxen offen sc0 sc1
K2_FS0:
    s_sub_u32 s57, s57, 1
    s_cbranch_scc1 K2_LSWFA1
K2_LSRFA1:
    ds_read_u16 v36, v3 offset:12
    ds_read_u16 v38, v3 offset:16
    ds_read_u16_d16_hi v106, v3 offset:14
    ds_read_u16_d16_hi v107, v3 offset:18
    s_cmp_lg_u32 s96, 0
    s_cbranch_scc1 K2_FS1
    s_waitcnt lgkmcnt(2)
    buffer_load_dwordx4 v[80:83], v[36:37], s[24:27], 0 idxen offen sc0 sc1
    buffer_load_dwordx4 v[84:87], v[38:39], s[24:27], 0 idxen offen sc0 sc1
K2_FS1:
    s_sub_u32 s57, s57, 1
    s_cbranch_scc1 K2_LSWFA2
K2_LSRFA2:
    ds_read_u16 v36, v3 offset:20
    ds_read_u16 v38, v3 offset:24
    ds_read_u16_d16_hi v108, v3 offset:22
    ds_read_u16_d16_hi v109, v3 offset:26
    s_cmp_lg_u32 s96, 0
    s_cbranch_scc1 K2_FS2
    s_waitcnt lgkmcnt(2)
    buffer_load_dwordx4 v[88:91], v[36:37], s[24:27], 0 idxen offen sc0 sc1
    buffer_load_dwordx4 v[92:95], v[38:39], s[24:27], 0 idxen offen sc0 sc1
K2_FS2:
    s_sub_u32 s57, s57, 1
    s_cbranch_scc1 K2_LSWFA3
K2_LSRFA3:
    ds_read_u16 v36, v3 offset:28
    ds_read_u16 v38, v3 offset:32
    ds_read_u16_d16_hi v110, v3 offset:30
    ds_read_u16_d16_hi v111, v3 offset:34
    v_add_u32 v3, 32, v3
    s_cmp_lg_u32 s96, 0
    s_cbranch_scc1 K2_FS3
    s_waitcnt lgkmcnt(2)
    buffer_load_dwordx4 v[96:99], v[36:37], s[24:27], 0 idxen offen sc0 sc1
    buffer_load_dwordx4 v[100:103], v[38:39], s[24:27], 0 idxen offen sc0 sc1
K2_FS3:
    v_lshlrev_b32 v12, 16, v120
    v_lshlrev_b32 v13, 16, v121
    v_lshlrev_b32 v16, 16, v122
    v_lshlrev_b32 v17, 16, v123
    v_add_u32 v31, v125, v32
    ds_read_b128 v[120:123], v31
    v_mov_b64 v[20:21], 0
    v_mov_b64 v[22:23], 0
    v_mov_b64 v[24:25], s[94:95]
    v_mov_b64 v[26:27], s[94:95]
    s_setprio 3
    s_cmp_eq_u32 s96, 0
    s_cbranch_scc1 K2_FW
    s_mov_b32 s96, 3
    s_waitcnt vmcnt(0) lgkmcnt(0)
K2_FW:
    s_waitcnt vmcnt(6)
    v_mfma_f32_4x4x4_16b_bf16 v[40:43], v[4:5], v[72:73], v[12:15]
    v_mfma_f32_4x4x4_16b_bf16 v[44:47], v[4:5], v[74:75], v[16:19]
    v_mfma_f32_4x4x4_16b_bf16 v[48:51], v[4:5], v[76:77], v[12:15]
    v_mfma_f32_4x4x4_16b_bf16 v[52:55], v[4:5], v[78:79], v[16:19]
    s_nop 4
    v_pk_fma_f32 v[40:41], v[104:105], v[6:7], v[40:41] op_sel:[0,0,0] op_sel_hi:[0,1,1]
    v_pk_fma_f32 v[44:45], v[104:105], v[8:9], v[44:45] op_sel:[0,0,0] op_sel_hi:[0,1,1]
    v_pk_fma_f32 v[48:49], v[104:105], v[6:7], v[48:49] op_sel:[1,0,0] op_sel_hi:[1,1,1]
    v_pk_fma_f32 v[52:53], v[104:105], v[8:9], v[52:53] op_sel:[1,0,0] op_sel_hi:[1,1,1]
    s_sub_u32 s57, s57, 1
    s_cbranch_scc1 K2_LSWG
K2_LSRG:
    ds_read_u16 v36, v3 offset:4
    ds_read_u16 v38, v3 offset:8
    ds_read_u16_d16_hi v104, v3 offset:6
    ds_read_u16_d16_hi v105, v3 offset:10
    s_branch K2_X0
K2_LOOP:
    v_pk_fma_f32 v[40:41], v[104:105], v[6:7], v[40:41] op_sel:[0,0,0] op_sel_hi:[0,1,1]
    v_pk_fma_f32 v[44:45], v[104:105], v[8:9], v[44:45] op_sel:[0,0,0] op_sel_hi:[0,1,1]
    v_pk_fma_f32 v[48:49], v[104:105], v[6:7], v[48:49] op_sel:[1,0,0] op_sel_hi:[1,1,1]
    v_pk_fma_f32 v[52:53], v[104:105], v[8:9], v[52:53] op_sel:[1,0,0] op_sel_hi:[1,1,1]
    s_sub_u32 s57, s57, 1
    s_cbranch_scc1 K2_LSW0
K2_LSR0:
    ds_read_u16 v36, v3 offset:4
    ds_read_u16 v38, v3 offset:8
    ds_read_u16_d16_hi v104, v3 offset:6
    ds_read_u16_d16_hi v105, v3 offset:10
    v_pk_fma_f32 v[20:21], v[20:21], v[56:57], v[20:21]
    v_pk_fma_f32 v[22:23], v[22:23], v[60:61], v[22:23]
    v_pk_fma_f32 v[20:21], v[58:59], v[24:25], v[20:21]
    v_pk_fma_f32 v[22:23], v[62:63], v[26:27], v[22:23]
    v_pk_fma_f32 v[24:25], v[24:25], v[56:57], v[24:25]
    v_pk_fma_f32 v[26:27], v[26:27], v[60:61], v[26:27]
    v_pk_fma_f32 v[20:21], v[20:21], v[64:65], v[20:21]
    v_pk_fma_f32 v[22:23], v[22:23], v[68:69], v[22:23]
    v_pk_fma_f32 v[20:21], v[66:67], v[24:25], v[20:21]
    v_pk_fma_f32 v[22:23], v[70:71], v[26:27], v[22:23]
    v_pk_fma_f32 v[24:25], v[24:25], v[64:65], v[24:25]
    v_pk_fma_f32 v[26:27], v[26:27], v[68:69], v[26:27]
    s_cmp_lg_u32 s101, 0
    s_cbranch_scc1 K2_FL0
K2_X0:
    s_sub_u32 s42, s42, 1
    s_cmp_eq_u32 s42, 0
    s_cbranch_scc1 K2_CSW0
K2_XR0:
    s_cmp_lg_u32 s96, 0
    s_waitcnt lgkmcnt(0)
    s_cbranch_scc1 K2_DR0
    buffer_load_dwordx4 v[72:75], v[36:37], s[24:27], 0 idxen offen sc0 sc1
    buffer_load_dwordx4 v[76:79], v[38:39], s[24:27], 0 idxen offen sc0 sc1
K2_DRR0:
    v_exp_f32 v40, v40
    s_waitcnt vmcnt(6)
    v_mfma_f32_4x4x4_16b_bf16 v[56:59], v[4:5], v[80:81], v[12:15]
    v_exp_f32 v41, v41
    v_mfma_f32_4x4x4_16b_bf16 v[60:63], v[4:5], v[82:83], v[16:19]
    v_exp_f32 v44, v44
    v_mfma_f32_4x4x4_16b_bf16 v[64:67], v[4:5], v[84:85], v[12:15]
    v_exp_f32 v45, v45
    v_mfma_f32_4x4x4_16b_bf16 v[68:71], v[4:5], v[86:87], v[16:19]
    v_exp_f32 v48, v48
    v_exp_f32 v49, v49
    v_exp_f32 v52, v52
    v_exp_f32 v53, v53
    v_pk_fma_f32 v[56:57], v[106:107], v[6:7], v[56:57] op_sel:[0,0,0] op_sel_hi:[0,1,1]
    v_pk_fma_f32 v[60:61], v[106:107], v[8:9], v[60:61] op_sel:[0,0,0] op_sel_hi:[0,1,1]
    v_pk_fma_f32 v[64:65], v[106:107], v[6:7], v[64:65] op_sel:[1,0,0] op_sel_hi:[1,1,1]
    v_pk_fma_f32 v[68:69], v[106:107], v[8:9], v[68:69] op_sel:[1,0,0] op_sel_hi:[1,1,1]
    s_sub_u32 s57, s57, 1
    s_cbranch_scc1 K2_LSW1
K2_LSR1:
    ds_read_u16 v36, v3 offset:12
    ds_read_u16 v38, v3 offset:16
    ds_read_u16_d16_hi v106, v3 offset:14
    ds_read_u16_d16_hi v107, v3 offset:18
    v_pk_fma_f32 v[20:21], v[20:21], v[40:41], v[20:21]
    v_pk_fma_f32 v[22:23], v[22:23], v[44:45], v[22:23]
    v_pk_fma_f32 v[20:21], v[42:43], v[24:25], v[20:21]
    v_pk_fma_f32 v[22:23], v[46:47], v[26:27], v[22:23]
    v_pk_fma_f32 v[24:25], v[24:25], v[40:41], v[24:25]
    v_pk_fma_f32 v[26:27], v[26:27], v[44:45], v[26:27]
    v_pk_fma_f32 v[20:21], v[20:21], v[48:49], v[20:21]
    v_pk_fma_f32 v[22:23], v[22:23], v[52:53], v[22:23]
    v_pk_fma_f32 v[20:21], v[50:51], v[24:25], v[20:21]
    v_pk_fma_f32 v[22:23], v[54:55], v[26:27], v[22:23]
    v_pk_fma_f32 v[24:25], v[24:25], v[48:49], v[24:25]
    v_pk_fma_f32 v[26:27], v[26:27], v[52:53], v[26:27]
    s_cmp_lg_u32 s101, 0
    s_cbranch_scc1 K2_FL1
K2_X1:
    s_sub_u32 s42, s42, 1
    s_cmp_eq_u32 s42, 0
    s_cbranch_scc1 K2_CSW1
K2_XR1:
    s_cmp_lg_u32 s96, 0
    s_waitcnt lgkmcnt(0)
    s_cbranch_scc1 K2_DR1
    buffer_load_dwordx4 v[80:83], v[36:37], s[24:27], 0 idxen offen sc0 sc1
    buffer_load_dwordx4 v[84:87], v[38:39], s[24:27], 0 idxen offen sc0 sc1
K2_DRR1:
    v_exp_f32 v56, v56
    s_waitcnt vmcnt(6)
    v_mfma_f32_4x4x4_16b_bf16 v[40:43], v[4:5], v[88:89], v[12:15]
    v_exp_f32 v57, v57
    v_mfma_f32_4x4x4_16b_bf16 v[44:47], v[4:5], v[90:91], v[16:19]
    v_exp_f32 v60, v60
    v_mfma_f32_4x4x4_16b_bf16 v[48:51], v[4:5], v[92:93], v[12:15]
    v_exp_f32 v61, v61
    v_mfma_f32_4x4x4_16b_bf16 v[52:55], v[4:5], v[94:95], v[16:19]
    v_exp_f32 v64, v64
    v_exp_f32 v65, v65
    v_exp_f32 v68, v68
    v_exp_f32 v69, v69
    v_pk_fma_f32 v[40:41], v[108:109], v[6:7], v[40:41] op_sel:[0,0,0] op_sel_hi:[0,1,1]
    v_pk_fma_f32 v[44:45], v[108:109], v[8:9], v[44:45] op_sel:[0,0,0] op_sel_hi:[0,1,1]
    v_pk_fma_f32 v[48:49], v[108:109], v[6:7], v[48:49] op_sel:[1,0,0] op_sel_hi:[1,1,1]
    v_pk_fma_f32 v[52:53], v[108:109], v[8:9], v[52:53] op_sel:[1,0,0] op_sel_hi:[1,1,1]
    s_sub_u32 s57, s57, 1
    s_cbranch_scc1 K2_LSW2
K2_LSR2:
    ds_read_u16 v36, v3 offset:20
    ds_read_u16 v38, v3 offset:24
    ds_read_u16_d16_hi v108, v3 offset:22
    ds_read_u16_d16_hi v109, v3 offset:26
    v_pk_fma_f32 v[20:21], v[20:21], v[56:57], v[20:21]
    v_pk_fma_f32 v[22:23], v[22:23], v[60:61], v[22:23]
    v_pk_fma_f32 v[20:21], v[58:59], v[24:25], v[20:21]
    v_pk_fma_f32 v[22:23], v[62:63], v[26:27], v[22:23]
    v_pk_fma_f32 v[24:25], v[24:25], v[56:57], v[24:25]
    v_pk_fma_f32 v[26:27], v[26:27], v[60:61], v[26:27]
    v_pk_fma_f32 v[20:21], v[20:21], v[64:65], v[20:21]
    v_pk_fma_f32 v[22:23], v[22:23], v[68:69], v[22:23]
    v_pk_fma_f32 v[20:21], v[66:67], v[24:25], v[20:21]
    v_pk_fma_f32 v[22:23], v[70:71], v[26:27], v[22:23]
    v_pk_fma_f32 v[24:25], v[24:25], v[64:65], v[24:25]
    v_pk_fma_f32 v[26:27], v[26:27], v[68:69], v[26:27]
    s_cmp_lg_u32 s101, 0
    s_cbranch_scc1 K2_FL2
K2_X2:
    s_sub_u32 s42, s42, 1
    s_cmp_eq_u32 s42, 0
    s_cbranch_scc1 K2_CSW2
K2_XR2:
    s_cmp_lg_u32 s96, 0
    s_waitcnt lgkmcnt(0)
    s_cbranch_scc1 K2_DR2
    buffer_load_dwordx4 v[88:91], v[36:37], s[24:27], 0 idxen offen sc0 sc1
    buffer_load_dwordx4 v[92:95], v[38:39], s[24:27], 0 idxen offen sc0 sc1
K2_DRR2:
    v_exp_f32 v40, v40
    s_waitcnt vmcnt(6)
    v_mfma_f32_4x4x4_16b_bf16 v[56:59], v[4:5], v[96:97], v[12:15]
    v_exp_f32 v41, v41
    v_mfma_f32_4x4x4_16b_bf16 v[60:63], v[4:5], v[98:99], v[16:19]
    v_exp_f32 v44, v44
    v_mfma_f32_4x4x4_16b_bf16 v[64:67], v[4:5], v[100:101], v[12:15]
    v_exp_f32 v45, v45
    v_mfma_f32_4x4x4_16b_bf16 v[68:71], v[4:5], v[102:103], v[16:19]
    v_exp_f32 v48, v48
    v_exp_f32 v49, v49
    v_exp_f32 v52, v52
    v_exp_f32 v53, v53
    v_pk_fma_f32 v[56:57], v[110:111], v[6:7], v[56:57] op_sel:[0,0,0] op_sel_hi:[0,1,1]
    v_pk_fma_f32 v[60:61], v[110:111], v[8:9], v[60:61] op_sel:[0,0,0] op_sel_hi:[0,1,1]
    v_pk_fma_f32 v[64:65], v[110:111], v[6:7], v[64:65] op_sel:[1,0,0] op_sel_hi:[1,1,1]
    v_pk_fma_f32 v[68:69], v[110:111], v[8:9], v[68:69] op_sel:[1,0,0] op_sel_hi:[1,1,1]
    s_sub_u32 s57, s57, 1
    s_cbranch_scc1 K2_LSW3
K2_LSR3:
    ds_read_u16 v36, v3 offset:28
    ds_read_u16 v38, v3 offset:32
    ds_read_u16_d16_hi v110, v3 offset:30
    ds_read_u16_d16_hi v111, v3 offset:34
    v_add_u32 v3, 32, v3
    v_pk_fma_f32 v[20:21], v[20:21], v[40:41], v[20:21]
    v_pk_fma_f32 v[22:23], v[22:23], v[44:45], v[22:23]
    v_pk_fma_f32 v[20:21], v[42:43], v[24:25], v[20:21]
    v_pk_fma_f32 v[22:23], v[46:47], v[26:27], v[22:23]
    v_pk_fma_f32 v[24:25], v[24:25], v[40:41], v[24:25]
    v_pk_fma_f32 v[26:27], v[26:27], v[44:45], v[26:27]
    v_pk_fma_f32 v[20:21], v[20:21], v[48:49], v[20:21]
    v_pk_fma_f32 v[22:23], v[22:23], v[52:53], v[22:23]
    v_pk_fma_f32 v[20:21], v[50:51], v[24:25], v[20:21]
    v_pk_fma_f32 v[22:23], v[54:55], v[26:27], v[22:23]
    v_pk_fma_f32 v[24:25], v[24:25], v[48:49], v[24:25]
    v_pk_fma_f32 v[26:27], v[26:27], v[52:53], v[26:27]
    s_cmp_lg_u32 s101, 0
    s_cbranch_scc1 K2_FL3
K2_X3:
    s_sub_u32 s42, s42, 1
    s_cmp_eq_u32 s42, 0
    s_cbranch_scc1 K2_CSW3
K2_XR3:
    s_cmp_lg_u32 s96, 0
    s_waitcnt lgkmcnt(0)
    s_cbranch_scc1 K2_DR3
    buffer_load_dwordx4 v[96:99], v[36:37], s[24:27], 0 idxen offen sc0 sc1
    buffer_load_dwordx4 v[100:103], v[38:39], s[24:27], 0 idxen offen sc0 sc1
K2_DRR3:
    v_exp_f32 v56, v56
    s_waitcnt vmcnt(6)
    v_mfma_f32_4x4x4_16b_bf16 v[40:43], v[4:5], v[72:73], v[12:15]
    v_exp_f32 v57, v57
    v_mfma_f32_4x4x4_16b_bf16 v[44:47], v[4:5], v[74:75], v[16:19]
    v_exp_f32 v60, v60
    v_mfma_f32_4x4x4_16b_bf16 v[48:51], v[4:5], v[76:77], v[12:15]
    v_exp_f32 v61, v61
    v_mfma_f32_4x4x4_16b_bf16 v[52:55], v[4:5], v[78:79], v[16:19]
    v_exp_f32 v64, v64
    v_exp_f32 v65, v65
    v_exp_f32 v68, v68
    v_exp_f32 v69, v69
    s_add_u32 s35, s42, s45
    s_cmp_gt_u32 s35, 12
    s_cbranch_scc1 K2_LOOP
    s_cmp_lg_u32 s96, 0
    s_cbranch_scc1 K2_LOOP
    s_setprio 2
    s_branch K2_LOOP
K2_LSWFA0:
    s_cmp_eq_u32 s58, 0
    s_cbranch_scc1 K2_LSEFA0
    s_add_u32 s56, s56, 1
    v_readlane_b32 s57, v35, s56
    s_lshl_b32 s35, s56, 6
    v_add_u32 v29, s35, v11
    s_waitcnt lgkmcnt(0)
    v_sub_u32_sdwa v3, v124, 0 dst_sel:DWORD dst_unused:UNUSED_PAD src0_sel:WORD_0 src1_sel:DWORD
    ds_read_b32 v124, v29 offset:64
    s_min_u32 s57, s57, s58
    s_sub_u32 s58, s58, s57
    s_sub_u32 s57, s57, 1
    s_branch K2_LSRFA0
K2_LSEFA0:
    s_mov_b32 s96, 1
    s_movk_i32 s57, 1000
    s_branch K2_LSRFA0
K2_LSWFA1:
    s_cmp_eq_u32 s58, 0
    s_cbranch_scc1 K2_LSEFA1
    s_add_u32 s56, s56, 1
    v_readlane_b32 s57, v35, s56
    s_lshl_b32 s35, s56, 6
    v_add_u32 v29, s35, v11
    s_waitcnt lgkmcnt(0)
    v_sub_u32_sdwa v3, v124, 8 dst_sel:DWORD dst_unused:UNUSED_PAD src0_sel:WORD_0 src1_sel:DWORD
    ds_read_b32 v124, v29 offset:64
    s_min_u32 s57, s57, s58
    s_sub_u32 s58, s58, s57
    s_sub_u32 s57, s57, 1
    s_branch K2_LSRFA1
K2_LSEFA1:
    s_mov_b32 s96, 1
    s_movk_i32 s57, 1000
    s_branch K2_LSRFA1
K2_LSWFA2:
    s_cmp_eq_u32 s58, 0
    s_cbranch_scc1 K2_LSEFA2
    s_add_u32 s56, s56, 1
    v_readlane_b32 s57, v35, s56
    s_lshl_b32 s35, s56, 6
    v_add_u32 v29, s35, v11
    s_waitcnt lgkmcnt(0)
    v_sub_u32_sdwa v3, v124, 16 dst_sel:DWORD dst_unused:UNUSED_PAD src0_sel:WORD_0 src1_sel:DWORD
    ds_read_b32 v124, v29 offset:64
    s_min_u32 s57, s57, s58
    s_sub_u32 s58, s58, s57
    s_sub_u32 s57, s57, 1
    s_branch K2_LSRFA2
K2_LSEFA2:
    s_mov_b32 s96, 1
    s_movk_i32 s57, 1000
    s_branch K2_LSRFA2
K2_LSWFA3:
    s_cmp_eq_u32 s58, 0
    s_cbranch_scc1 K2_LSEFA3
    s_add_u32 s56, s56, 1
    v_readlane_b32 s57, v35, s56
    s_lshl_b32 s35, s56, 6
    v_add_u32 v29, s35, v11
    s_waitcnt lgkmcnt(0)
    v_sub_u32_sdwa v3, v124, 24 dst_sel:DWORD dst_unused:UNUSED_PAD src0_sel:WORD_0 src1_sel:DWORD
    ds_read_b32 v124, v29 offset:64
    s_min_u32 s57, s57, s58
    s_sub_u32 s58, s58, s57
    s_sub_u32 s57, s57, 1
    s_branch K2_LSRFA3
K2_LSEFA3:
    s_mov_b32 s96, 1
    s_movk_i32 s57, 1000
    s_branch K2_LSRFA3
K2_LSWG:
    s_cmp_eq_u32 s58, 0
    s_cbranch_scc1 K2_LSEG
    s_add_u32 s56, s56, 1
    v_readlane_b32 s57, v35, s56
    s_lshl_b32 s35, s56, 6
    v_add_u32 v29, s35, v11
    s_waitcnt lgkmcnt(0)
    v_sub_u32_sdwa v3, v124, 0 dst_sel:DWORD dst_unused:UNUSED_PAD src0_sel:WORD_0 src1_sel:DWORD
    ds_read_b32 v124, v29 offset:64
    s_min_u32 s57, s57, s58
    s_sub_u32 s58, s58, s57
    s_sub_u32 s57, s57, 1
    s_branch K2_LSRG
K2_LSEG:
    s_mov_b32 s96, 1
    s_movk_i32 s57, 1000
    s_branch K2_LSRG
K2_LSW0:
    s_cmp_eq_u32 s58, 0
    s_cbranch_scc1 K2_LSE0
    s_add_u32 s56, s56, 1
    v_readlane_b32 s57, v35, s56
    s_lshl_b32 s35, s56, 6
    v_add_u32 v29, s35, v11
    s_waitcnt lgkmcnt(0)
    v_sub_u32_sdwa v3, v124, 0 dst_sel:DWORD dst_unused:UNUSED_PAD src0_sel:WORD_0 src1_sel:DWORD
    ds_read_b32 v124, v29 offset:64
    s_min_u32 s57, s57, s58
    s_sub_u32 s58, s58, s57
    s_sub_u32 s57, s57, 1
    s_branch K2_LSR0
K2_LSE0:
    s_mov_b32 s96, 1
    s_movk_i32 s57, 1000
    s_branch K2_LSR0
K2_LSW1:
    s_cmp_eq_u32 s58, 0
    s_cbranch_scc1 K2_LSE1
    s_add_u32 s56, s56, 1
    v_readlane_b32 s57, v35, s56
    s_lshl_b32 s35, s56, 6
    v_add_u32 v29, s35, v11
    s_waitcnt lgkmcnt(0)
    v_sub_u32_sdwa v3, v124, 8 dst_sel:DWORD dst_unused:UNUSED_PAD src0_sel:WORD_0 src1_sel:DWORD
    ds_read_b32 v124, v29 offset:64
    s_min_u32 s57, s57, s58
    s_sub_u32 s58, s58, s57
    s_sub_u32 s57, s57, 1
    s_branch K2_LSR1
K2_LSE1:
    s_mov_b32 s96, 1
    s_movk_i32 s57, 1000
    s_branch K2_LSR1
K2_LSW2:
    s_cmp_eq_u32 s58, 0
    s_cbranch_scc1 K2_LSE2
    s_add_u32 s56, s56, 1
    v_readlane_b32 s57, v35, s56
    s_lshl_b32 s35, s56, 6
    v_add_u32 v29, s35, v11
    s_waitcnt lgkmcnt(0)
    v_sub_u32_sdwa v3, v124, 16 dst_sel:DWORD dst_unused:UNUSED_PAD src0_sel:WORD_0 src1_sel:DWORD
    ds_read_b32 v124, v29 offset:64
    s_min_u32 s57, s57, s58
    s_sub_u32 s58, s58, s57
    s_sub_u32 s57, s57, 1
    s_branch K2_LSR2
K2_LSE2:
    s_mov_b32 s96, 1
    s_movk_i32 s57, 1000
    s_branch K2_LSR2
K2_LSW3:
    s_cmp_eq_u32 s58, 0
    s_cbranch_scc1 K2_LSE3
    s_add_u32 s56, s56, 1
    v_readlane_b32 s57, v35, s56
    s_lshl_b32 s35, s56, 6
    v_add_u32 v29, s35, v11
    s_waitcnt lgkmcnt(0)
    v_sub_u32_sdwa v3, v124, 24 dst_sel:DWORD dst_unused:UNUSED_PAD src0_sel:WORD_0 src1_sel:DWORD
    ds_read_b32 v124, v29 offset:64
    s_min_u32 s57, s57, s58
    s_sub_u32 s58, s58, s57
    s_sub_u32 s57, s57, 1
    s_branch K2_LSR3
K2_LSE3:
    s_mov_b32 s96, 1
    s_movk_i32 s57, 1000
    s_branch K2_LSR3
K2_DR0:
    s_add_u32 s96, s96, 1
    s_setprio 1
    s_waitcnt vmcnt(4)
    s_cmp_eq_u32 s96, 2
    s_cbranch_scc1 K2_DRR0
    s_setprio 1
    s_waitcnt vmcnt(2)
    s_cmp_eq_u32 s96, 3
    s_cbranch_scc1 K2_DRR0
    s_setprio 1
    s_waitcnt vmcnt(0)
    s_branch K2_DRR0
K2_CSW0:
    ds_read_b128 v[112:115], v30
    s_cmp_eq_u32 s45, 0
    s_cbranch_scc1 K2_LAST0
    s_add_u32 s43, s43, 1
    v_readlane_b32 s42, v35, s43
    s_lshl_b32 s35, s43, 6
    v_add_u32 v29, s35, v11
    s_mov_b32 s101, 1
    s_waitcnt lgkmcnt(1)
    v_lshlrev_b32 v12, 16, v120
    v_lshlrev_b32 v13, 16, v121
    v_lshlrev_b32 v16, 16, v122
    v_lshlrev_b32 v17, 16, v123
    ds_read_b32 v125, v29 offset:68
    s_min_u32 s42, s42, s45
    s_sub_u32 s45, s45, s42
    s_branch K2_XR0
K2_FL0:
    s_mov_b32 s62, 0
    s_branch K2_FL
K2_DR1:
    s_add_u32 s96, s96, 1
    s_setprio 1
    s_waitcnt vmcnt(4)
    s_cmp_eq_u32 s96, 2
    s_cbranch_scc1 K2_DRR1
    s_setprio 1
    s_waitcnt vmcnt(2)
    s_cmp_eq_u32 s96, 3
    s_cbranch_scc1 K2_DRR1
    s_setprio 1
    s_waitcnt vmcnt(0)
    s_branch K2_DRR1
K2_CSW1:
    ds_read_b128 v[112:115], v30
    s_cmp_eq_u32 s45, 0
    s_cbranch_scc1 K2_LAST1
    s_add_u32 s43, s43, 1
    v_readlane_b32 s42, v35, s43
    s_lshl_b32 s35, s43, 6
    v_add_u32 v29, s35, v11
    s_mov_b32 s101, 1
    s_waitcnt lgkmcnt(1)
    v_lshlrev_b32 v12, 16, v120
    v_lshlrev_b32 v13, 16, v121
    v_lshlrev_b32 v16, 16, v122
    v_lshlrev_b32 v17, 16, v123
    ds_read_b32 v125, v29 offset:68
    s_min_u32 s42, s42, s45
    s_sub_u32 s45, s45, s42
    s_branch K2_XR1
K2_FL1:
    s_mov_b32 s62, 1
    s_branch K2_FL
K2_DR2:
    s_add_u32 s96, s96, 1
    s_setprio 1
    s_waitcnt vmcnt(4)
    s_cmp_eq_u32 s96, 2
    s_cbranch_scc1 K2_DRR2
    s_setprio 1
    s_waitcnt vmcnt(2)
    s_cmp_eq_u32 s96, 3
    s_cbranch_scc1 K2_DRR2
    s_setprio 1
    s_waitcnt vmcnt(0)
    s_branch K2_DRR2
K2_CSW2:
    ds_read_b128 v[112:115], v30
    s_cmp_eq_u32 s45, 0
    s_cbranch_scc1 K2_LAST0
    s_add_u32 s43, s43, 1
    v_readlane_b32 s42, v35, s43
    s_lshl_b32 s35, s43, 6
    v_add_u32 v29, s35, v11
    s_mov_b32 s101, 1
    s_waitcnt lgkmcnt(1)
    v_lshlrev_b32 v12, 16, v120
    v_lshlrev_b32 v13, 16, v121
    v_lshlrev_b32 v16, 16, v122
    v_lshlrev_b32 v17, 16, v123
    ds_read_b32 v125, v29 offset:68
    s_min_u32 s42, s42, s45
    s_sub_u32 s45, s45, s42
    s_branch K2_XR2
K2_FL2:
    s_mov_b32 s62, 2
    s_branch K2_FL
K2_DR3:
    s_add_u32 s96, s96, 1
    s_setprio 1
    s_waitcnt vmcnt(4)
    s_cmp_eq_u32 s96, 2
    s_cbranch_scc1 K2_DRR3
    s_setprio 1
    s_waitcnt vmcnt(2)
    s_cmp_eq_u32 s96, 3
    s_cbranch_scc1 K2_DRR3
    s_setprio 1
    s_waitcnt vmcnt(0)
    s_branch K2_DRR3
K2_CSW3:
    ds_read_b128 v[112:115], v30
    s_cmp_eq_u32 s45, 0
    s_cbranch_scc1 K2_LAST1
    s_add_u32 s43, s43, 1
    v_readlane_b32 s42, v35, s43
    s_lshl_b32 s35, s43, 6
    v_add_u32 v29, s35, v11
    s_mov_b32 s101, 1
    s_waitcnt lgkmcnt(1)
    v_lshlrev_b32 v12, 16, v120
    v_lshlrev_b32 v13, 16, v121
    v_lshlrev_b32 v16, 16, v122
    v_lshlrev_b32 v17, 16, v123
    ds_read_b32 v125, v29 offset:68
    s_min_u32 s42, s42, s45
    s_sub_u32 s45, s45, s42
    s_branch K2_XR3
K2_FL3:
    s_mov_b32 s62, 3
K2_FL:
    v_max3_f32 v10, v10, v24, v25
    v_max3_f32 v10, v10, v26, v27
    v_rcp_f32 v24, v24
    v_rcp_f32 v25, v25
    v_rcp_f32 v26, v26
    v_rcp_f32 v27, v27
    s_cmp_lg_u32 s44, 0
    s_cbranch_scc1 K2_FLS
    v_and_b32 v112, s100, v112
    v_and_b32 v113, s100, v113
    v_and_b32 v114, s100, v114
    v_and_b32 v115, s100, v115
    v_pk_fma_f32 v[112:113], v[20:21], v[24:25], v[112:113]
    v_pk_fma_f32 v[114:115], v[22:23], v[26:27], v[114:115]
    v_cmp_gt_u32 vcc, 79616, v30
    v_pk_mul_f32 v[116:117], v[112:113], s[40:41]
    v_pk_mul_f32 v[118:119], v[114:115], s[40:41]
    s_mov_b64 exec, vcc
    v_exp_f32 v116, v116
    v_exp_f32 v117, v117
    v_exp_f32 v118, v118
    v_exp_f32 v119, v119
    v_pk_add_f32 v[28:29], v[112:113], v[114:115]
    v_pk_add_f32 v[116:117], v[116:117], 1.0 op_sel_hi:[1,0]
    v_pk_add_f32 v[118:119], v[118:119], 1.0 op_sel_hi:[1,0]
    v_add_f32 v28, v28, v29
    v_rcp_f32 v116, v116
    v_rcp_f32 v117, v117
    v_rcp_f32 v118, v118
    v_rcp_f32 v119, v119
    v_cmp_class_f32 vcc, v28, s93
    v_add_u32 v28, v30, v127
    v_pk_mul_f32 v[112:113], v[112:113], v[116:117]
    v_pk_mul_f32 v[114:115], v[114:115], v[118:119]
    s_or_b64 s[46:47], s[46:47], vcc
    v_cvt_pk_bf16_f32 v116, v112, v113
    v_cvt_pk_bf16_f32 v117, v114, v115
    buffer_store_dwordx2 v[116:117], v28, s[16:19], 0 offen sc0 sc1
    s_mov_b64 exec, -1
    s_branch K2_FLE
K2_FLS:
    s_lshl_b32 s35, s3, 10
    s_add_u32 s35, s35, 105728
    v_add_u32 v28, s35, v33
    v_pk_mul_f32 v[20:21], v[20:21], v[24:25]
    v_pk_mul_f32 v[22:23], v[22:23], v[26:27]
    ds_write_b128 v28, v[20:23]
    s_lshl_b32 s35, s3, 2
    v_mov_b32 v29, s35
    ds_write_b32 v29, v11 offset:54208
    s_mov_b32 s44, 0
K2_FLE:
    v_mov_b32 v30, v31
    v_add_u32 v31, v125, v32
    ds_read_b128 v[120:123], v31
    s_mov_b32 s101, 0
    v_mov_b64 v[20:21], 0
    v_mov_b64 v[22:23], 0
    v_mov_b64 v[24:25], s[94:95]
    v_mov_b64 v[26:27], s[94:95]
    s_cmp_eq_u32 s62, 0
    s_cbranch_scc1 K2_X0
    s_cmp_eq_u32 s62, 1
    s_cbranch_scc1 K2_X1
    s_cmp_eq_u32 s62, 2
    s_cbranch_scc1 K2_X2
    s_branch K2_X3
K2_LAST0:
    v_readlane_b32 s36, v34, s43
    v_readlane_b32 s37, v35, s43
    s_add_u32 s42, s3, 1
    s_lshl_b32 s35, s42, 2
    v_mov_b32 v29, s35
    s_lshl_b32 s35, s42, 10
    s_add_u32 s35, s35, 105728
    v_add_u32 v28, s35, v33
    ds_read_b32 v31, v29 offset:54208
    ds_read_b128 v[116:119], v28
    s_add_u32 s36, s36, s37
    s_mul_i32 s57, s42, s39
    s_add_u32 s58, s57, s39
    s_lshr_b32 s57, s57, 4
    s_lshr_b32 s58, s58, 4
    s_setprio 0
    v_exp_f32 v40, v40
    v_exp_f32 v41, v41
    v_exp_f32 v44, v44
    v_exp_f32 v45, v45
    v_exp_f32 v48, v48
    v_exp_f32 v49, v49
    v_exp_f32 v52, v52
    v_exp_f32 v53, v53
    v_pk_fma_f32 v[20:21], v[20:21], v[40:41], v[20:21]
    v_pk_fma_f32 v[22:23], v[22:23], v[44:45], v[22:23]
    v_pk_fma_f32 v[20:21], v[42:43], v[24:25], v[20:21]
    v_pk_fma_f32 v[22:23], v[46:47], v[26:27], v[22:23]
    v_pk_fma_f32 v[24:25], v[24:25], v[40:41], v[24:25]
    v_pk_fma_f32 v[26:27], v[26:27], v[44:45], v[26:27]
    v_pk_fma_f32 v[20:21], v[20:21], v[48:49], v[20:21]
    v_pk_fma_f32 v[22:23], v[22:23], v[52:53], v[22:23]
    v_pk_fma_f32 v[20:21], v[50:51], v[24:25], v[20:21]
    v_pk_fma_f32 v[22:23], v[54:55], v[26:27], v[22:23]
    v_pk_fma_f32 v[24:25], v[24:25], v[48:49], v[24:25]
    v_pk_fma_f32 v[26:27], v[26:27], v[52:53], v[26:27]
    s_branch K2_FLUSH
K2_LAST1:
    v_readlane_b32 s36, v34, s43
    v_readlane_b32 s37, v35, s43
    s_add_u32 s42, s3, 1
    s_lshl_b32 s35, s42, 2
    v_mov_b32 v29, s35
    s_lshl_b32 s35, s42, 10
    s_add_u32 s35, s35, 105728
    v_add_u32 v28, s35, v33
    ds_read_b32 v31, v29 offset:54208
    ds_read_b128 v[116:119], v28
    s_add_u32 s36, s36, s37
    s_mul_i32 s57, s42, s39
    s_add_u32 s58, s57, s39
    s_lshr_b32 s57, s57, 4
    s_lshr_b32 s58, s58, 4
    s_setprio 0
    v_exp_f32 v56, v56
    v_exp_f32 v57, v57
    v_exp_f32 v60, v60
    v_exp_f32 v61, v61
    v_exp_f32 v64, v64
    v_exp_f32 v65, v65
    v_exp_f32 v68, v68
    v_exp_f32 v69, v69
    v_pk_fma_f32 v[20:21], v[20:21], v[56:57], v[20:21]
    v_pk_fma_f32 v[22:23], v[22:23], v[60:61], v[22:23]
    v_pk_fma_f32 v[20:21], v[58:59], v[24:25], v[20:21]
    v_pk_fma_f32 v[22:23], v[62:63], v[26:27], v[22:23]
    v_pk_fma_f32 v[24:25], v[24:25], v[56:57], v[24:25]
    v_pk_fma_f32 v[26:27], v[26:27], v[60:61], v[26:27]
    v_pk_fma_f32 v[20:21], v[20:21], v[64:65], v[20:21]
    v_pk_fma_f32 v[22:23], v[22:23], v[68:69], v[22:23]
    v_pk_fma_f32 v[20:21], v[66:67], v[24:25], v[20:21]
    v_pk_fma_f32 v[22:23], v[70:71], v[26:27], v[22:23]
    v_pk_fma_f32 v[24:25], v[24:25], v[64:65], v[24:25]
    v_pk_fma_f32 v[26:27], v[26:27], v[68:69], v[26:27]
K2_FLUSH:
    v_max3_f32 v10, v10, v24, v25
    v_max3_f32 v10, v10, v26, v27
    v_rcp_f32 v24, v24
    v_rcp_f32 v25, v25
    v_rcp_f32 v26, v26
    v_rcp_f32 v27, v27
    s_cmp_lg_u32 s44, 0
    s_cbranch_scc0 K2_FH
    s_lshl_b32 s35, s3, 10
    s_add_u32 s35, s35, 105728
    v_add_u32 v28, s35, v33
    v_pk_mul_f32 v[20:21], v[20:21], v[24:25]
    v_pk_mul_f32 v[22:23], v[22:23], v[26:27]
    ds_write_b128 v28, v[20:23]
    s_lshl_b32 s35, s3, 2
    v_mov_b32 v29, s35
    ds_write_b32 v29, v11 offset:54208
    s_branch K2_FE
K2_FH:
    s_waitcnt lgkmcnt(0)
    v_cmp_eq_u32 vcc, 0, v31
    v_and_b32 v112, s100, v112
    v_and_b32 v113, s100, v113
    v_and_b32 v114, s100, v114
    v_and_b32 v115, s100, v115
    v_pk_fma_f32 v[112:113], v[20:21], v[24:25], v[112:113]
    v_pk_fma_f32 v[114:115], v[22:23], v[26:27], v[114:115]
    s_cmp_ge_u32 s57, s36
    s_cbranch_scc1 K2_FHD
    s_cbranch_vccnz K2_FHS
    v_pk_add_f32 v[112:113], v[112:113], v[116:117]
    v_pk_add_f32 v[114:115], v[114:115], v[118:119]
    s_cmp_ge_u32 s58, s36
    s_cbranch_scc1 K2_FHD
    s_branch K2_FHL
K2_FHS:
    s_mov_b32 s42, s3
K2_FHL:
    s_add_u32 s42, s42, 1
    s_mul_i32 s35, s42, s39
    s_add_u32 s37, s35, s39
    s_lshr_b32 s35, s35, 4
    s_lshr_b32 s37, s37, 4
    s_cmp_ge_u32 s35, s36
    s_cbranch_scc1 K2_FHD
    s_cmp_eq_u32 s35, s37
    s_cbranch_scc1 K2_FHL
    s_lshl_b32 s35, s42, 2
    v_mov_b32 v29, s35
    s_lshl_b32 s35, s42, 10
    s_add_u32 s35, s35, 105728
    v_add_u32 v28, s35, v33
K2_FHW:
    ds_read_b32 v31, v29 offset:54208
    ds_read_b128 v[116:119], v28
    s_waitcnt lgkmcnt(0)
    v_cmp_eq_u32 vcc, 0, v31
    s_cbranch_vccz K2_FHA
    s_setprio 0
    s_sleep 2
    s_branch K2_FHW
K2_FHA:
    v_pk_add_f32 v[112:113], v[112:113], v[116:117]
    v_pk_add_f32 v[114:115], v[114:115], v[118:119]
    s_branch K2_FHL
K2_FHD:
    v_cmp_gt_u32 vcc, 79616, v30
    v_pk_mul_f32 v[116:117], v[112:113], s[40:41]
    v_pk_mul_f32 v[118:119], v[114:115], s[40:41]
    s_mov_b64 exec, vcc
    v_exp_f32 v116, v116
    v_exp_f32 v117, v117
    v_exp_f32 v118, v118
    v_exp_f32 v119, v119
    v_pk_add_f32 v[28:29], v[112:113], v[114:115]
    v_pk_add_f32 v[116:117], v[116:117], 1.0 op_sel_hi:[1,0]
    v_pk_add_f32 v[118:119], v[118:119], 1.0 op_sel_hi:[1,0]
    v_add_f32 v28, v28, v29
    v_rcp_f32 v116, v116
    v_rcp_f32 v117, v117
    v_rcp_f32 v118, v118
    v_rcp_f32 v119, v119
    v_cmp_class_f32 vcc, v28, s93
    v_add_u32 v28, v30, v127
    v_pk_mul_f32 v[112:113], v[112:113], v[116:117]
    v_pk_mul_f32 v[114:115], v[114:115], v[118:119]
    s_or_b64 s[46:47], s[46:47], vcc
    v_cvt_pk_bf16_f32 v116, v112, v113
    v_cvt_pk_bf16_f32 v117, v114, v115
    buffer_store_dwordx2 v[116:117], v28, s[16:19], 0 offen sc0 sc1
    s_mov_b64 exec, -1
K2_FE:
    s_setprio 0
    s_branch K2_LOOPDONE
K_ALONE:
    s_mov_b32 s34, 1
    s_waitcnt vmcnt(0)
    v_mov_b32 v42, 0
    s_nop 1
    s_branch K_RANK
K2_RESTART:
    s_mov_b32 s34, 1
    s_waitcnt vmcnt(0) lgkmcnt(0)
    s_barrier
    s_load_dwordx4 s[48:51], s[0:1], 40
    s_cmp_ge_u32 s3, 4
    s_cbranch_scc1 K_AW
    v_lshrrev_b32 v28, 2, v1
    v_lshlrev_b32 v28, 7, v28
    v_and_or_b32 v28, v33, 48, v28
    s_lshl_b32 s44, s3, 11
    s_add_u32 m0, s44, 105728
    s_and_b32 s45, s3, 1
    s_lshl_b32 s45, s45, 12
    s_lshl_b32 s46, s33, 6
    s_add_u32 s45, s45, s46
    s_cmp_lt_u32 s3, 2
    s_cselect_b32 s47, 8192, 0
    s_mov_b32 s30, 16512
    s_mov_b32 s31, 0x20000
    s_waitcnt lgkmcnt(0)
    s_cselect_b64 s[28:29], s[50:51], s[48:49]
    s_add_u32 s45, s45, s47
    s_add_u32 s47, s45, 1024
    buffer_load_dwordx4 v28, s[28:31], s45 offen lds
    buffer_load_dwordx4 v28, s[28:31], s47 offen offset:1024 lds
K_AW:
    s_waitcnt vmcnt(0) lgkmcnt(0)
    s_barrier
    s_cmp_ge_u32 s3, 7
    s_cbranch_scc1 K_AL1
    s_movk_i32 s42, 112
    v_lshrrev_b32 v121, 3, v1
    s_lshl_b32 s35, s3, 5
    v_add_lshl_u32 v121, v121, s35, 7
    v_lshlrev_b32 v30, 4, v1
    v_xor_b32 v31, v30, v1
    v_and_or_b32 v121, v31, s42, v121
    s_lshl_b32 s36, s3, 12
    s_add_u32 s37, s36, 80128
    v_and_b32 v29, 31, v1
    v_lshl_add_u32 v29, v29, 7, s37
    v_bfe_u32 v30, v1, 1, 3
    v_lshrrev_b32 v120, 5, v1
    v_xor_b32 v30, v30, v120
    v_lshl_add_u32 v36, v30, 4, v29
    v_xor_b32 v37, 32, v36
    v_xor_b32 v38, 64, v36
    v_xor_b32 v39, 96, v36
    v_lshlrev_b32 v120, 9, v120
    v_bfe_u32 v29, v1, 2, 2
    v_lshl_add_u32 v120, v29, 6, v120
    v_bfe_u32 v29, v1, 4, 1
    v_lshl_add_u32 v120, v29, 5, v120
    v_and_b32 v29, 3, v1
    v_lshl_add_u32 v120, v29, 3, v120
    v_add_u32 v120, 105728, v120
    v_lshrrev_b32 v123, 5, v1
    v_lshlrev_b32 v123, 9, v123
    v_and_b32 v30, 31, v1
    v_lshl_add_u32 v123, v30, 2, v123
    v_add_u32 v123, s36, v123
    s_mov_b32 s43, 0
K_AL:
    s_lshl_b32 s35, s3, 12
    s_add_u32 m0, s35, 80128
    v_add_u32 v28, s43, v121
    v_xor_b32 v29, 64, v28
    buffer_load_dwordx4 v28, s[8:11], 0 offen lds
    s_cmp_eq_u32 s3, 6
    s_cbranch_scc1 XD_B
    buffer_load_dwordx4 v29, s[8:11], 0 offen offset:1024 lds
    buffer_load_dwordx4 v28, s[8:11], 0 offen offset:2048 lds
    buffer_load_dwordx4 v29, s[8:11], 0 offen offset:3072 lds
XD_B:
    s_waitcnt vmcnt(0)
    ds_read_b128 v[40:43], v36
    ds_read_b128 v[44:47], v37
    ds_read_b128 v[48:51], v38
    ds_read_b128 v[52:55], v39
    ds_read_b64_tr_b16 v[56:57], v120 offset:0
    ds_read_b64_tr_b16 v[58:59], v120 offset:256
    ds_read_b64_tr_b16 v[60:61], v120 offset:1024
    ds_read_b64_tr_b16 v[62:63], v120 offset:1280
    ds_read_b64_tr_b16 v[64:65], v120 offset:2048
    ds_read_b64_tr_b16 v[66:67], v120 offset:2304
    ds_read_b64_tr_b16 v[68:69], v120 offset:3072
    ds_read_b64_tr_b16 v[70:71], v120 offset:3328
    s_waitcnt lgkmcnt(4)
    ds_read_b64_tr_b16 v[72:73], v120 offset:4096
    ds_read_b64_tr_b16 v[74:75], v120 offset:4352
    ds_read_b64_tr_b16 v[76:77], v120 offset:5120
    ds_read_b64_tr_b16 v[78:79], v120 offset:5376
    ds_read_b64_tr_b16 v[80:81], v120 offset:6144
    ds_read_b64_tr_b16 v[82:83], v120 offset:6400
    ds_read_b64_tr_b16 v[84:85], v120 offset:7168
    ds_read_b64_tr_b16 v[86:87], v120 offset:7424
    v_mfma_f32_32x32x16_bf16 v[88:103], v[40:43], v[56:59], 0
    v_mfma_f32_32x32x16_bf16 v[88:103], v[44:47], v[60:63], v[88:103]
    s_waitcnt lgkmcnt(10)
    v_mfma_f32_32x32x16_bf16 v[88:103], v[48:51], v[64:67], v[88:103]
    s_waitcnt lgkmcnt(8)
    v_mfma_f32_32x32x16_bf16 v[88:103], v[52:55], v[68:71], v[88:103]
    s_waitcnt lgkmcnt(6)
    v_mfma_f32_32x32x16_bf16 v[104:119], v[40:43], v[72:75], 0
    s_waitcnt lgkmcnt(4)
    v_mfma_f32_32x32x16_bf16 v[104:119], v[44:47], v[76:79], v[104:119]
    s_waitcnt lgkmcnt(2)
    v_mfma_f32_32x32x16_bf16 v[104:119], v[48:51], v[80:83], v[104:119]
    s_waitcnt lgkmcnt(0)
    v_mfma_f32_32x32x16_bf16 v[104:119], v[52:55], v[84:87], v[104:119]
    v_add_u32 v122, s43, v123
    s_nop 6
    v_pk_mul_f32 v[88:89], v[88:89], s[40:41]
    v_pk_mul_f32 v[90:91], v[90:91], s[40:41]
    v_pk_mul_f32 v[92:93], v[92:93], s[40:41]
    v_pk_mul_f32 v[94:95], v[94:95], s[40:41]
    v_pk_mul_f32 v[96:97], v[96:97], s[40:41]
    v_pk_mul_f32 v[98:99], v[98:99], s[40:41]
    v_pk_mul_f32 v[100:101], v[100:101], s[40:41]
    v_pk_mul_f32 v[102:103], v[102:103], s[40:41]
    v_cvt_pk_bf16_f32 v88, v88, v104
    v_cvt_pk_bf16_f32 v89, v89, v105
    v_cvt_pk_bf16_f32 v90, v90, v106
    v_cvt_pk_bf16_f32 v91, v91, v107
    v_cvt_pk_bf16_f32 v92, v92, v108
    v_cvt_pk_bf16_f32 v93, v93, v109
    v_cvt_pk_bf16_f32 v94, v94, v110
    v_cvt_pk_bf16_f32 v95, v95, v111
    v_cvt_pk_bf16_f32 v96, v96, v112
    v_cvt_pk_bf16_f32 v97, v97, v113
    v_cvt_pk_bf16_f32 v98, v98, v114
    v_cvt_pk_bf16_f32 v99, v99, v115
    v_cvt_pk_bf16_f32 v100, v100, v116
    v_cvt_pk_bf16_f32 v101, v101, v117
    v_cvt_pk_bf16_f32 v102, v102, v118
    v_cvt_pk_bf16_f32 v103, v103, v119
    s_cmp_eq_u32 s3, 6
    s_cbranch_scc1 T6_C
    buffer_store_dword v88, v122, s[20:23], 0 offen offset:0 sc0 sc1
    buffer_store_dword v89, v122, s[20:23], 0 offen offset:128 sc0 sc1
    buffer_store_dword v90, v122, s[20:23], 0 offen offset:256 sc0 sc1
    buffer_store_dword v91, v122, s[20:23], 0 offen offset:384 sc0 sc1
    buffer_store_dword v92, v122, s[20:23], 0 offen offset:1024 sc0 sc1
    buffer_store_dword v93, v122, s[20:23], 0 offen offset:1152 sc0 sc1
    buffer_store_dword v94, v122, s[20:23], 0 offen offset:1280 sc0 sc1
    buffer_store_dword v95, v122, s[20:23], 0 offen offset:1408 sc0 sc1
    buffer_store_dword v96, v122, s[20:23], 0 offen offset:2048 sc0 sc1
    buffer_store_dword v97, v122, s[20:23], 0 offen offset:2176 sc0 sc1
    buffer_store_dword v98, v122, s[20:23], 0 offen offset:2304 sc0 sc1
    buffer_store_dword v99, v122, s[20:23], 0 offen offset:2432 sc0 sc1
    buffer_store_dword v100, v122, s[20:23], 0 offen offset:3072 sc0 sc1
    buffer_store_dword v101, v122, s[20:23], 0 offen offset:3200 sc0 sc1
    buffer_store_dword v102, v122, s[20:23], 0 offen offset:3328 sc0 sc1
    buffer_store_dword v103, v122, s[20:23], 0 offen offset:3456 sc0 sc1
    s_branch TD_C
T6_C:
    s_mov_b32 exec_hi, 0
    buffer_store_dword v88, v122, s[20:23], 0 offen offset:0 sc0 sc1
    buffer_store_dword v89, v122, s[20:23], 0 offen offset:128 sc0 sc1
    buffer_store_dword v90, v122, s[20:23], 0 offen offset:256 sc0 sc1
    buffer_store_dword v91, v122, s[20:23], 0 offen offset:384 sc0 sc1
    s_mov_b64 exec, -1
TD_C:
    s_add_u32 s43, s43, 25088
    s_cmp_lt_u32 s43, 3211264
    s_cbranch_scc1 K_AL
    s_waitcnt vmcnt(0)
K_AL1:
    v_lshlrev_b32 v28, 4, v0
    v_mov_b64 v[44:45], 0
    v_mov_b64 v[46:47], 0
    ds_write_b128 v28, v[44:47] offset:0
    ds_write_b128 v28, v[44:47] offset:16384
    ds_write_b128 v28, v[44:47] offset:32768
    v_cmp_gt_u32 vcc, 192, v0
    s_mov_b64 exec, vcc
    ds_write_b128 v28, v[44:47] offset:49152
    s_mov_b64 exec, -1
    s_waitcnt lgkmcnt(0)
    s_barrier
    s_load_dwordx4 s[48:51], s[0:1], 8
    s_load_dwordx2 s[52:53], s[0:1], 24
    s_waitcnt lgkmcnt(0)
    s_mov_b64 s[56:57], s[48:49]
    s_mov_b32 s58, 1600000
    s_mov_b32 s59, 0x20000
    s_mov_b64 s[60:61], s[50:51]
    s_mov_b32 s62, 3200000
    s_mov_b32 s63, 0x20000
    s_mov_b64 s[64:65], s[52:53]
    s_mov_b32 s66, 3200000
    s_mov_b32 s67, 0x20000
    s_mov_b32 s37, 0xffff0000
    s_mul_i32 s36, s32, 196
    s_lshl_b32 s43, s3, 6
    v_mov_b32 v37, v2
K2_SBLK:
    v_add_lshl_u32 v68, v1, s43, 2
    buffer_load_dword v40, v68, s[64:67], 0 offen
    s_waitcnt vmcnt(0)
    v_subrev_u32 v40, s36, v40
    v_cmp_gt_u32 vcc, 196, v40
    s_mov_b64 s[68:69], vcc
K2_SGRP:
    s_ff1_i32_b64 s70, s[68:69]
    s_cmp_lt_i32 s70, 0
    s_cbranch_scc1 K2_SNEXT
    s_and_b32 s70, s70, 56
    s_lshl_b64 s[72:73], 0xff, s70
    s_andn2_b64 s[68:69], s[68:69], s[72:73]
    v_lshrrev_b32 v71, 3, v1
    v_add_u32 v71, s70, v71
    v_lshlrev_b32 v70, 2, v71
    ds_bpermute_b32 v69, v70, v40
    v_add_u32 v71, s43, v71
    v_lshlrev_b32 v68, 2, v71
    v_lshlrev_b32 v71, 1, v71
    s_waitcnt lgkmcnt(0)
    v_cmp_gt_u32 vcc, 196, v69
    s_mov_b64 exec, vcc
    buffer_load_dword v36, v68, s[60:63], 0 offen
    buffer_load_ushort v43, v71, s[56:59], 0 offen
    v_lshl_add_u32 v29, v69, 7, v32
    ds_read_b128 v[48:51], v29
    s_waitcnt vmcnt(0)
    buffer_load_dwordx4 v[44:47], v[36:37], s[24:27], 0 idxen offen sc0 sc1
    v_lshlrev_b32 v43, 16, v43
    v_subrev_u32 v29, 54528, v29
    v_lshlrev_b32 v29, 1, v29
    s_waitcnt vmcnt(0) lgkmcnt(0)
    v_lshlrev_b32 v52, 16, v44
    v_lshlrev_b32 v48, 16, v48
    v_and_b32 v56, s37, v44
    v_add_f32 v52, v52, v48
    v_fmac_f32 v52, v43, v6
    v_lshlrev_b32 v53, 16, v45
    v_lshlrev_b32 v49, 16, v49
    v_and_b32 v57, s37, v45
    v_add_f32 v53, v53, v49
    v_fmac_f32 v53, v43, v7
    v_lshlrev_b32 v54, 16, v46
    v_lshlrev_b32 v50, 16, v50
    v_and_b32 v58, s37, v46
    v_add_f32 v54, v54, v50
    v_fmac_f32 v54, v43, v8
    v_lshlrev_b32 v55, 16, v47
    v_lshlrev_b32 v51, 16, v51
    v_and_b32 v59, s37, v47
    v_add_f32 v55, v55, v51
    v_fmac_f32 v55, v43, v9
    v_exp_f32 v52, v52
    v_exp_f32 v53, v53
    v_exp_f32 v54, v54
    v_exp_f32 v55, v55
    v_add_f32 v52, 1.0, v52
    v_add_f32 v53, 1.0, v53
    v_add_f32 v54, 1.0, v54
    v_add_f32 v55, 1.0, v55
    v_rcp_f32 v52, v52
    v_rcp_f32 v53, v53
    v_rcp_f32 v54, v54
    v_rcp_f32 v55, v55
    v_mul_f32 v52, v52, v56
    v_mul_f32 v53, v53, v57
    v_mul_f32 v54, v54, v58
    v_mul_f32 v55, v55, v59
    v_cvt_f64_f32 v[60:61], v52
    ds_add_f64 v29, v[60:61] offset:0
    v_cvt_f64_f32 v[62:63], v53
    ds_add_f64 v29, v[62:63] offset:8
    v_cvt_f64_f32 v[64:65], v54
    ds_add_f64 v29, v[64:65] offset:16
    v_cvt_f64_f32 v[66:67], v55
    ds_add_f64 v29, v[66:67] offset:24
    s_mov_b64 exec, -1
    s_waitcnt lgkmcnt(0)
    s_branch K2_SGRP
K2_SNEXT:
    s_add_u32 s43, s43, 1024
    s_cmp_lt_u32 s43, 800000
    s_cbranch_scc1 K2_SBLK
    s_movk_i32 s38, 128
    s_mov_b32 s100, 0xffff0000
    s_movk_i32 s93, 0x207
    s_mov_b64 s[46:47], 0
    s_mul_i32 s35, s32, 25088
    s_lshl_b32 s36, s33, 6
    s_add_u32 s35, s35, s36
    s_sub_u32 s35, s35, 54528
    v_lshrrev_b32 v127, 1, v2
    v_sub_u32 v127, s35, v127
    s_waitcnt vmcnt(0) lgkmcnt(0)
    s_barrier
K2_LOOPDONE:
    s_mov_b32 s43, s3
    s_cmp_lg_u32 s34, 0
    s_cbranch_scc1 K2_EP
    s_cmp_lg_u32 s61, 0
    s_cbranch_scc1 K2_EPX
K2_EP:
    v_readlane_b32 s36, v35, s43
    s_cmp_lg_u32 s34, 0
    s_cselect_b32 s36, 0, s36
    s_cmp_lg_u32 s36, 0
    s_cbranch_scc1 K2_EPN
    s_lshl_b32 s35, s43, 6
    v_add_u32 v28, s35, v11
    ds_read_b32 v30, v28 offset:4
    v_mov_b64 v[40:41], 0
    v_mov_b64 v[42:43], 0
    s_waitcnt lgkmcnt(0)
    v_add_u32 v30, v30, v32
    ds_read_b128 v[44:47], v30
    s_cmp_eq_u32 s34, 0
    s_cbranch_scc1 K2_EPF
    v_subrev_u32 v28, 54528, v30
    v_lshlrev_b32 v28, 1, v28
    ds_read_b128 v[56:59], v28
    ds_read_b128 v[60:63], v28 offset:16
    s_waitcnt lgkmcnt(0)
    v_cvt_f32_f64 v40, v[56:57]
    v_cvt_f32_f64 v41, v[58:59]
    v_cvt_f32_f64 v42, v[60:61]
    v_cvt_f32_f64 v43, v[62:63]
K2_EPF:
    s_waitcnt lgkmcnt(0)
    v_and_b32 v44, s100, v44
    v_and_b32 v45, s100, v45
    v_and_b32 v46, s100, v46
    v_and_b32 v47, s100, v47
    v_pk_add_f32 v[40:41], v[40:41], v[44:45]
    v_pk_add_f32 v[42:43], v[42:43], v[46:47]
    v_cmp_gt_u32 vcc, 79616, v30
    v_pk_mul_f32 v[44:45], v[40:41], s[40:41]
    v_pk_mul_f32 v[46:47], v[42:43], s[40:41]
    s_mov_b64 exec, vcc
    v_exp_f32 v44, v44
    v_exp_f32 v45, v45
    v_exp_f32 v46, v46
    v_exp_f32 v47, v47
    v_pk_add_f32 v[28:29], v[40:41], v[42:43]
    v_pk_add_f32 v[44:45], v[44:45], 1.0 op_sel_hi:[1,0]
    v_pk_add_f32 v[46:47], v[46:47], 1.0 op_sel_hi:[1,0]
    v_add_f32 v28, v28, v29
    v_rcp_f32 v44, v44
    v_rcp_f32 v45, v45
    v_rcp_f32 v46, v46
    v_rcp_f32 v47, v47
    v_cmp_class_f32 vcc, v28, s93
    v_add_u32 v28, v30, v127
    v_pk_mul_f32 v[40:41], v[40:41], v[44:45]
    v_pk_mul_f32 v[42:43], v[42:43], v[46:47]
    s_or_b64 s[46:47], s[46:47], vcc
    v_cvt_pk_bf16_f32 v44, v40, v41
    v_cvt_pk_bf16_f32 v45, v42, v43
    buffer_store_dwordx2 v[44:45], v28, s[16:19], 0 offen sc0 sc1
    s_mov_b64 exec, -1
K2_EPN:
    s_add_u32 s43, s43, 16
    s_cmp_lt_u32 s43, 25
    s_cbranch_scc1 K2_EP
    s_cmp_lg_u32 s34, 0
    s_cbranch_scc1 K2_DONE
K2_EPX:
    s_mov_b32 s35, 0x7b800000
    v_cmp_lt_f32 vcc, s35, v10
    v_mov_b32 v28, 53888
    s_or_b64 exec, s[46:47], vcc
    ds_write_b32 v28, v28
    s_mov_b64 exec, -1
    s_waitcnt lgkmcnt(0)
    s_barrier
    ds_read_b32 v28, v28
    s_waitcnt lgkmcnt(0)
    v_readfirstlane_b32 s35, v28
    s_cmp_lg_u32 s35, 0
    s_cbranch_scc1 K2_RESTART
K2_DONE:
K2_END:
    s_endpgm
K2_CODE_END:
.section .rodata,"a"
.p2align 6
.amdhsa_kernel gather_scatter__edge_featured_mpnn_egc__graph_kernel
  .amdhsa_next_free_vgpr 128
  .amdhsa_next_free_sgpr 102
  .amdhsa_accum_offset 128
  .amdhsa_group_segment_fixed_size 0
  .amdhsa_kernarg_size 80
  .amdhsa_user_sgpr_count 2
  .amdhsa_user_sgpr_kernarg_segment_ptr 1
  .amdhsa_system_sgpr_workgroup_id_x 1
  .amdhsa_float_denorm_mode_32 3
.end_amdhsa_kernel
```
